```python
import torch

def _softmax(x, axis=-1):
    return torch.softmax(x, dim=axis)
def _gelu(x):
    return torch.nn.functional.gelu(x, approximate="tanh")
def _silu(x):
    return torch.nn.functional.silu(x)
def _sigmoid(x):
    return torch.sigmoid(x)
def _layernorm(x, axis=-1, eps=1e-5):
    m = x.mean(dim=axis, keepdim=True)
    v = x.var(dim=axis, keepdim=True, unbiased=False)
    return (x - m) / torch.sqrt(v + eps)
def _scatter_add(tgt, idx, src, axis=0):
    return tgt.clone().index_add_(axis, idx, src)
def _segment_sum(src, seg, n):
    out = torch.zeros((n,) + src.shape[1:], dtype=src.dtype)
    return out.index_add_(0, seg, src)
def _pad(x, pw):
    flat = tuple(v for pair in reversed(pw) for v in pair)
    return torch.nn.functional.pad(x, flat)

kernel_name = 'recurrent_scan__spectral_gfnet__dense_activation_silu__prompt'

def setup_inputs():

    _w = (lambda a: (lambda t: t.to(torch.bfloat16) if t.is_floating_point() else t)(torch.as_tensor(a)))
    def _A_setup():
        B, S, D = 1, 2048, 512
        Df = D // 2 + 1
        return {
            "x": _w((lambda *s: torch.randn(*s, dtype=torch.bfloat16) * 0.05)(B, S, D)),
            "w_r": _w((lambda *s: torch.randn(*s, dtype=torch.bfloat16) * 3.2)(S, Df) * 0.02),
            "w_i": _w((lambda *s: torch.randn(*s, dtype=torch.bfloat16) * 3.2)(S, Df) * 0.02),
        }
    _A_in = _A_setup()

    def _B_setup():
        B, S, D, F = 1, 2048, 512, 1376
        return {
            "x": _w((lambda *s: torch.randn(*s, dtype=torch.bfloat16) * 0.05)(B, S, D)),
            "w1": _w((lambda *s: torch.randn(*s, dtype=torch.bfloat16) * 3.2)(D, F) * (D ** -0.5)),
            "w2": _w((lambda *s: torch.randn(*s, dtype=torch.bfloat16) * 0.4)(F, D) * (F ** -0.5)),
        }
    _B_in = _B_setup()

    return {
        "A_x": _A_in["x"],
        "A_w_r": _A_in["w_r"],
        "A_w_i": _A_in["w_i"],
        "B_x": _B_in["x"],
        "B_w1": _B_in["w1"],
        "B_w2": _B_in["w2"],
    }

def reference(A_x, A_w_r, A_w_i, B_x, B_w1, B_w2):
    def _A_ref(x, w_r, w_i):
        B, S, D = x.shape
        X = (lambda x, axes=(-2,-1): torch.fft.rfft2(x.float(), dim=axes))(x, axes=(-2, -1))
        W = w_r + 1j * w_i
        X = X * W
        y = (lambda x, s, axes=(-2,-1): torch.fft.irfft2(x, s=s, dim=axes).to(torch.bfloat16))(X, (S, D), axes=(-2, -1))
        return y

    def _B_ref(x, w1, w2):
        h = torch.einsum("bsd,df->bsf", x, w1)
        h = _silu(h)
        out = torch.einsum("bsf,fd->bsd", h, w2)
        return out

    x = A_x
    xn = _layernorm(x, axis=-1)
    s = _A_ref(xn, A_w_r, A_w_i)
    g = _silu(_B_ref(xn, B_w1, B_w2))
    return x + s * g
```

```asm
; @launch kernel=l1_kernel grid=(592,1,1) block=(256,1,1) lds=67584
; @launch kernel=l2_kernel grid=(385,1,1) block=(256,1,1) lds=49152
; @launch kernel=k4_kernel grid=(256,1,1) block=(256,1,1) lds=17408
.amdgcn_target "amdgcn-amd-amdhsa--gfx950"
.text
.globl l1_kernel
.p2align 8
.type l1_kernel,@function
l1_kernel:
    s_cmp_ge_u32 s2, 592
    s_cbranch_scc1 Lend_l1
    s_cmp_lt_u32 s2, 176
    s_cbranch_scc1 Lrole_l1_0
    s_branch Lrole_l1_1
Lrole_l1_0:
    s_cmp_ge_u32 s2, 176
    s_cbranch_scc1 Lend_g1
    s_load_dwordx2 s[6:7], s[0:1], 64
    s_load_dwordx2 s[4:5], s[0:1], 32
    s_load_dwordx2 s[34:35], s[0:1], 0
    s_waitcnt lgkmcnt(0)
    s_mov_b32 s12, s6
    s_and_b32 s13, s7, 0xffff
    s_mov_b32 s14, 268435456
    s_mov_b32 s15, 0x00020000
    s_mov_b32 s8, s4
    s_and_b32 s9, s5, 0xffff
    s_mov_b32 s10, 1409024
    s_mov_b32 s11, 0x00020000
    s_mov_b32 s36, s34
    s_and_b32 s37, s35, 0xffff
    s_mov_b32 s38, 2097152
    s_mov_b32 s39, 0x00020000
    s_and_b32 s20, s2, 15
    s_lshr_b32 s21, s2, 4
    v_lshrrev_b32 v1, 6, v0
    v_and_b32 v2, 63, v0
    v_readfirstlane_b32 s30, v1
    v_lshrrev_b32 v3, 2, v2
    v_and_b32 v4, 3, v2
    v_bfe_u32 v5, v2, 4, 2
    v_xor_b32 v4, v4, v5
    s_mov_b32 s24, 1024
    s_mul_i32 s22, s20, 131072
    s_mul_i32 s25, s30, 32768
    s_add_u32 s22, s22, s25
    v_add_u32 v6, 0, v3
    v_mul_lo_u32 v6, v6, s24
    v_lshl_add_u32 v6, v4, 4, v6
    v_add_u32 v10, s22, v6
    v_add_u32 v6, 16, v3
    v_mul_lo_u32 v6, v6, s24
    v_lshl_add_u32 v6, v4, 4, v6
    v_add_u32 v11, s22, v6
    v_lshrrev_b32 v3, 4, v2
    v_and_b32 v4, 15, v2
    v_and_b32 v5, 3, v3
    v_lshlrev_b32 v5, 2, v5
    v_xor_b32 v4, v4, v5
    s_mov_b32 s24, 2752
    s_mul_i32 s23, s21, 256
    s_mul_i32 s25, s30, 22016
    s_add_u32 s23, s23, s25
    v_add_u32 v6, 0, v3
    v_mul_lo_u32 v6, v6, s24
    v_lshl_add_u32 v6, v4, 4, v6
    v_add_u32 v12, s23, v6
    v_add_u32 v6, 4, v3
    v_mul_lo_u32 v6, v6, s24
    v_lshl_add_u32 v6, v4, 4, v6
    v_add_u32 v13, s23, v6
    s_mul_i32 s31, s30, 2048
    s_mul_i32 s32, s30, 2048
    s_add_u32 s32, s32, 8192
    v_and_b32 v3, 1, v1
    v_lshrrev_b32 v4, 1, v1
    v_and_b32 v5, 31, v2
    v_lshrrev_b32 v6, 5, v2
    v_mul_u32_u24 v7, 64, v3
    v_add_u32 v7, v7, v5
    v_lshlrev_b32 v7, 6, v7
    v_bfe_u32 v8, v5, 2, 2
    v_add_u32 v9, 0, v6
    v_xor_b32 v9, v9, v8
    v_lshl_add_u32 v14, v9, 4, v7
    v_add_u32 v9, 2, v6
    v_xor_b32 v9, v9, v8
    v_lshl_add_u32 v15, v9, 4, v7
    v_bfe_u32 v7, v2, 2, 2
    v_lshl_add_u32 v8, v6, 3, v7
    v_lshlrev_b32 v8, 8, v8
    v_bfe_u32 v9, v2, 4, 1
    v_lshl_add_u32 v8, v9, 5, v8
    v_and_b32 v9, 3, v2
    v_lshl_add_u32 v8, v9, 3, v8
    v_add_u32 v8, 8192, v8
    v_mul_u32_u24 v9, 2, v4
    v_add_u32 v9, 0, v9
    v_xor_b32 v9, v9, v7
    v_lshl_add_u32 v16, v9, 6, v8
    v_mul_u32_u24 v9, 2, v4
    v_add_u32 v9, 1, v9
    v_xor_b32 v9, v9, v7
    v_lshl_add_u32 v17, v9, 6, v8
    v_mov_b32 v56, 0
    v_mov_b32 v57, 0
    v_mov_b32 v58, 0
    v_mov_b32 v59, 0
    v_mov_b32 v60, 0
    v_mov_b32 v61, 0
    v_mov_b32 v62, 0
    v_mov_b32 v63, 0
    v_mov_b32 v64, 0
    v_mov_b32 v65, 0
    v_mov_b32 v66, 0
    v_mov_b32 v67, 0
    v_mov_b32 v68, 0
    v_mov_b32 v69, 0
    v_mov_b32 v70, 0
    v_mov_b32 v71, 0
    v_mov_b32 v72, 0
    v_mov_b32 v73, 0
    v_mov_b32 v74, 0
    v_mov_b32 v75, 0
    v_mov_b32 v76, 0
    v_mov_b32 v77, 0
    v_mov_b32 v78, 0
    v_mov_b32 v79, 0
    v_mov_b32 v80, 0
    v_mov_b32 v81, 0
    v_mov_b32 v82, 0
    v_mov_b32 v83, 0
    v_mov_b32 v84, 0
    v_mov_b32 v85, 0
    v_mov_b32 v86, 0
    v_mov_b32 v87, 0
    v_mov_b32 v88, 0
    v_mov_b32 v89, 0
    v_mov_b32 v90, 0
    v_mov_b32 v91, 0
    v_mov_b32 v92, 0
    v_mov_b32 v93, 0
    v_mov_b32 v94, 0
    v_mov_b32 v95, 0
    v_mov_b32 v96, 0
    v_mov_b32 v97, 0
    v_mov_b32 v98, 0
    v_mov_b32 v99, 0
    v_mov_b32 v100, 0
    v_mov_b32 v101, 0
    v_mov_b32 v102, 0
    v_mov_b32 v103, 0
    v_mov_b32 v104, 0
    v_mov_b32 v105, 0
    v_mov_b32 v106, 0
    v_mov_b32 v107, 0
    v_mov_b32 v108, 0
    v_mov_b32 v109, 0
    v_mov_b32 v110, 0
    v_mov_b32 v111, 0
    v_mov_b32 v112, 0
    v_mov_b32 v113, 0
    v_mov_b32 v114, 0
    v_mov_b32 v115, 0
    v_mov_b32 v116, 0
    v_mov_b32 v117, 0
    v_mov_b32 v118, 0
    v_mov_b32 v119, 0
    v_mov_b32 v120, 0
    v_mov_b32 v121, 0
    v_lshrrev_b32 v20, 1, v0
    v_and_b32 v21, 1, v0
    v_lshlrev_b32 v22, 6, v20
    v_lshl_add_u32 v22, v21, 5, v22
    v_mov_b32 v124, 0
    v_mov_b32 v125, 0
    s_mov_b32 s33, 0x3f803f80
    s_add_u32 m0, s31, 0
    s_mov_b32 s26, 0
    buffer_load_dwordx4 v10, s[36:39], s26 offen lds
    s_add_u32 m0, s31, 1024
    s_mov_b32 s26, 0
    buffer_load_dwordx4 v11, s[36:39], s26 offen lds
    s_add_u32 m0, s32, 0
    s_mov_b32 s26, 0
    buffer_load_dwordx4 v12, s[8:11], s26 offen lds
    s_add_u32 m0, s32, 1024
    s_mov_b32 s26, 0
    buffer_load_dwordx4 v13, s[8:11], s26 offen lds
    s_add_u32 m0, s31, 16384
    s_mov_b32 s26, 64
    buffer_load_dwordx4 v10, s[36:39], s26 offen lds
    s_add_u32 m0, s31, 17408
    s_mov_b32 s26, 64
    buffer_load_dwordx4 v11, s[36:39], s26 offen lds
    s_add_u32 m0, s32, 16384
    s_mov_b32 s26, 88064
    buffer_load_dwordx4 v12, s[8:11], s26 offen lds
    s_add_u32 m0, s32, 17408
    s_mov_b32 s26, 88064
    buffer_load_dwordx4 v13, s[8:11], s26 offen lds
    s_add_u32 m0, s31, 32768
    s_mov_b32 s26, 128
    buffer_load_dwordx4 v10, s[36:39], s26 offen lds
    s_add_u32 m0, s31, 33792
    s_mov_b32 s26, 128
    buffer_load_dwordx4 v11, s[36:39], s26 offen lds
    s_add_u32 m0, s32, 32768
    s_mov_b32 s26, 176128
    buffer_load_dwordx4 v12, s[8:11], s26 offen lds
    s_add_u32 m0, s32, 33792
    s_mov_b32 s26, 176128
    buffer_load_dwordx4 v13, s[8:11], s26 offen lds
    s_waitcnt vmcnt(8)
    s_barrier
    s_add_u32 m0, s31, 49152
    s_mov_b32 s26, 192
    buffer_load_dwordx4 v10, s[36:39], s26 offen lds
    s_add_u32 m0, s31, 50176
    s_mov_b32 s26, 192
    buffer_load_dwordx4 v11, s[36:39], s26 offen lds
    s_add_u32 m0, s32, 49152
    s_mov_b32 s26, 264192
    buffer_load_dwordx4 v12, s[8:11], s26 offen lds
    s_add_u32 m0, s32, 50176
    s_mov_b32 s26, 264192
    buffer_load_dwordx4 v13, s[8:11], s26 offen lds
    ds_read_b128 v[24:27], v14 offset:0
    ds_read_b128 v[28:31], v14 offset:2048
    ds_read_b64_tr_b16 v[32:33], v16 offset:0
    ds_read_b64_tr_b16 v[34:35], v16 offset:1024
    ds_read_b64_tr_b16 v[36:37], v17 offset:0
    ds_read_b64_tr_b16 v[38:39], v17 offset:1024
    ds_read_b128 v[40:43], v15 offset:0
    ds_read_b128 v[44:47], v15 offset:2048
    ds_read_b64_tr_b16 v[48:49], v16 offset:4096
    ds_read_b64_tr_b16 v[50:51], v16 offset:5120
    ds_read_b64_tr_b16 v[52:53], v17 offset:4096
    ds_read_b64_tr_b16 v[54:55], v17 offset:5120
    ds_read_b128 v[128:131], v22 offset:0
    ds_read_b128 v[132:135], v22 offset:16
    s_waitcnt lgkmcnt(8)
    v_mfma_f32_32x32x16_bf16 v[56:71], v[32:35], v[24:27], v[56:71]
    v_mfma_f32_32x32x16_bf16 v[72:87], v[36:39], v[24:27], v[72:87]
    v_mfma_f32_32x32x16_bf16 v[88:103], v[32:35], v[28:31], v[88:103]
    v_mfma_f32_32x32x16_bf16 v[104:119], v[36:39], v[28:31], v[104:119]
    v_dot2_f32_bf16 v120, v32, s33, v120
    v_dot2_f32_bf16 v120, v33, s33, v120
    v_dot2_f32_bf16 v120, v34, s33, v120
    v_dot2_f32_bf16 v120, v35, s33, v120
    v_dot2_f32_bf16 v121, v36, s33, v121
    v_dot2_f32_bf16 v121, v37, s33, v121
    v_dot2_f32_bf16 v121, v38, s33, v121
    v_dot2_f32_bf16 v121, v39, s33, v121
    s_waitcnt lgkmcnt(0)
    v_mfma_f32_32x32x16_bf16 v[56:71], v[48:51], v[40:43], v[56:71]
    v_mfma_f32_32x32x16_bf16 v[72:87], v[52:55], v[40:43], v[72:87]
    v_mfma_f32_32x32x16_bf16 v[88:103], v[48:51], v[44:47], v[88:103]
    v_mfma_f32_32x32x16_bf16 v[104:119], v[52:55], v[44:47], v[104:119]
    v_dot2_f32_bf16 v120, v48, s33, v120
    v_dot2_f32_bf16 v120, v49, s33, v120
    v_dot2_f32_bf16 v120, v50, s33, v120
    v_dot2_f32_bf16 v120, v51, s33, v120
    v_dot2_f32_bf16 v121, v52, s33, v121
    v_dot2_f32_bf16 v121, v53, s33, v121
    v_dot2_f32_bf16 v121, v54, s33, v121
    v_dot2_f32_bf16 v121, v55, s33, v121
    v_dot2_f32_bf16 v124, v128, s33, v124
    v_dot2_f32_bf16 v125, v128, v128, v125
    v_dot2_f32_bf16 v124, v129, s33, v124
    v_dot2_f32_bf16 v125, v129, v129, v125
    v_dot2_f32_bf16 v124, v130, s33, v124
    v_dot2_f32_bf16 v125, v130, v130, v125
    v_dot2_f32_bf16 v124, v131, s33, v124
    v_dot2_f32_bf16 v125, v131, v131, v125
    v_dot2_f32_bf16 v124, v132, s33, v124
    v_dot2_f32_bf16 v125, v132, v132, v125
    v_dot2_f32_bf16 v124, v133, s33, v124
    v_dot2_f32_bf16 v125, v133, v133, v125
    v_dot2_f32_bf16 v124, v134, s33, v124
    v_dot2_f32_bf16 v125, v134, v134, v125
    v_dot2_f32_bf16 v124, v135, s33, v124
    v_dot2_f32_bf16 v125, v135, v135, v125
    s_waitcnt vmcnt(8)
    s_barrier
    s_add_u32 m0, s31, 0
    s_mov_b32 s26, 256
    buffer_load_dwordx4 v10, s[36:39], s26 offen lds
    s_add_u32 m0, s31, 1024
    s_mov_b32 s26, 256
    buffer_load_dwordx4 v11, s[36:39], s26 offen lds
    s_add_u32 m0, s32, 0
    s_mov_b32 s26, 352256
    buffer_load_dwordx4 v12, s[8:11], s26 offen lds
    s_add_u32 m0, s32, 1024
    s_mov_b32 s26, 352256
    buffer_load_dwordx4 v13, s[8:11], s26 offen lds
    ds_read_b128 v[24:27], v14 offset:16384
    ds_read_b128 v[28:31], v14 offset:18432
    ds_read_b64_tr_b16 v[32:33], v16 offset:16384
    ds_read_b64_tr_b16 v[34:35], v16 offset:17408
    ds_read_b64_tr_b16 v[36:37], v17 offset:16384
    ds_read_b64_tr_b16 v[38:39], v17 offset:17408
    ds_read_b128 v[40:43], v15 offset:16384
    ds_read_b128 v[44:47], v15 offset:18432
    ds_read_b64_tr_b16 v[48:49], v16 offset:20480
    ds_read_b64_tr_b16 v[50:51], v16 offset:21504
    ds_read_b64_tr_b16 v[52:53], v17 offset:20480
    ds_read_b64_tr_b16 v[54:55], v17 offset:21504
    ds_read_b128 v[128:131], v22 offset:16384
    ds_read_b128 v[132:135], v22 offset:16400
    s_waitcnt lgkmcnt(8)
    v_mfma_f32_32x32x16_bf16 v[56:71], v[32:35], v[24:27], v[56:71]
    v_mfma_f32_32x32x16_bf16 v[72:87], v[36:39], v[24:27], v[72:87]
    v_mfma_f32_32x32x16_bf16 v[88:103], v[32:35], v[28:31], v[88:103]
    v_mfma_f32_32x32x16_bf16 v[104:119], v[36:39], v[28:31], v[104:119]
    v_dot2_f32_bf16 v120, v32, s33, v120
    v_dot2_f32_bf16 v120, v33, s33, v120
    v_dot2_f32_bf16 v120, v34, s33, v120
    v_dot2_f32_bf16 v120, v35, s33, v120
    v_dot2_f32_bf16 v121, v36, s33, v121
    v_dot2_f32_bf16 v121, v37, s33, v121
    v_dot2_f32_bf16 v121, v38, s33, v121
    v_dot2_f32_bf16 v121, v39, s33, v121
    s_waitcnt lgkmcnt(0)
    v_mfma_f32_32x32x16_bf16 v[56:71], v[48:51], v[40:43], v[56:71]
    v_mfma_f32_32x32x16_bf16 v[72:87], v[52:55], v[40:43], v[72:87]
    v_mfma_f32_32x32x16_bf16 v[88:103], v[48:51], v[44:47], v[88:103]
    v_mfma_f32_32x32x16_bf16 v[104:119], v[52:55], v[44:47], v[104:119]
    v_dot2_f32_bf16 v120, v48, s33, v120
    v_dot2_f32_bf16 v120, v49, s33, v120
    v_dot2_f32_bf16 v120, v50, s33, v120
    v_dot2_f32_bf16 v120, v51, s33, v120
    v_dot2_f32_bf16 v121, v52, s33, v121
    v_dot2_f32_bf16 v121, v53, s33, v121
    v_dot2_f32_bf16 v121, v54, s33, v121
    v_dot2_f32_bf16 v121, v55, s33, v121
    v_dot2_f32_bf16 v124, v128, s33, v124
    v_dot2_f32_bf16 v125, v128, v128, v125
    v_dot2_f32_bf16 v124, v129, s33, v124
    v_dot2_f32_bf16 v125, v129, v129, v125
    v_dot2_f32_bf16 v124, v130, s33, v124
    v_dot2_f32_bf16 v125, v130, v130, v125
    v_dot2_f32_bf16 v124, v131, s33, v124
    v_dot2_f32_bf16 v125, v131, v131, v125
    v_dot2_f32_bf16 v124, v132, s33, v124
    v_dot2_f32_bf16 v125, v132, v132, v125
    v_dot2_f32_bf16 v124, v133, s33, v124
    v_dot2_f32_bf16 v125, v133, v133, v125
    v_dot2_f32_bf16 v124, v134, s33, v124
    v_dot2_f32_bf16 v125, v134, v134, v125
    v_dot2_f32_bf16 v124, v135, s33, v124
    v_dot2_f32_bf16 v125, v135, v135, v125
    s_waitcnt vmcnt(8)
    s_barrier
    s_add_u32 m0, s31, 16384
    s_mov_b32 s26, 320
    buffer_load_dwordx4 v10, s[36:39], s26 offen lds
    s_add_u32 m0, s31, 17408
    s_mov_b32 s26, 320
    buffer_load_dwordx4 v11, s[36:39], s26 offen lds
    s_add_u32 m0, s32, 16384
    s_mov_b32 s26, 440320
    buffer_load_dwordx4 v12, s[8:11], s26 offen lds
    s_add_u32 m0, s32, 17408
    s_mov_b32 s26, 440320
    buffer_load_dwordx4 v13, s[8:11], s26 offen lds
    ds_read_b128 v[24:27], v14 offset:32768
    ds_read_b128 v[28:31], v14 offset:34816
    ds_read_b64_tr_b16 v[32:33], v16 offset:32768
    ds_read_b64_tr_b16 v[34:35], v16 offset:33792
    ds_read_b64_tr_b16 v[36:37], v17 offset:32768
    ds_read_b64_tr_b16 v[38:39], v17 offset:33792
    ds_read_b128 v[40:43], v15 offset:32768
    ds_read_b128 v[44:47], v15 offset:34816
    ds_read_b64_tr_b16 v[48:49], v16 offset:36864
    ds_read_b64_tr_b16 v[50:51], v16 offset:37888
    ds_read_b64_tr_b16 v[52:53], v17 offset:36864
    ds_read_b64_tr_b16 v[54:55], v17 offset:37888
    ds_read_b128 v[128:131], v22 offset:32768
    ds_read_b128 v[132:135], v22 offset:32784
    s_waitcnt lgkmcnt(8)
    v_mfma_f32_32x32x16_bf16 v[56:71], v[32:35], v[24:27], v[56:71]
    v_mfma_f32_32x32x16_bf16 v[72:87], v[36:39], v[24:27], v[72:87]
    v_mfma_f32_32x32x16_bf16 v[88:103], v[32:35], v[28:31], v[88:103]
    v_mfma_f32_32x32x16_bf16 v[104:119], v[36:39], v[28:31], v[104:119]
    v_dot2_f32_bf16 v120, v32, s33, v120
    v_dot2_f32_bf16 v120, v33, s33, v120
    v_dot2_f32_bf16 v120, v34, s33, v120
    v_dot2_f32_bf16 v120, v35, s33, v120
    v_dot2_f32_bf16 v121, v36, s33, v121
    v_dot2_f32_bf16 v121, v37, s33, v121
    v_dot2_f32_bf16 v121, v38, s33, v121
    v_dot2_f32_bf16 v121, v39, s33, v121
    s_waitcnt lgkmcnt(0)
    v_mfma_f32_32x32x16_bf16 v[56:71], v[48:51], v[40:43], v[56:71]
    v_mfma_f32_32x32x16_bf16 v[72:87], v[52:55], v[40:43], v[72:87]
    v_mfma_f32_32x32x16_bf16 v[88:103], v[48:51], v[44:47], v[88:103]
    v_mfma_f32_32x32x16_bf16 v[104:119], v[52:55], v[44:47], v[104:119]
    v_dot2_f32_bf16 v120, v48, s33, v120
    v_dot2_f32_bf16 v120, v49, s33, v120
    v_dot2_f32_bf16 v120, v50, s33, v120
    v_dot2_f32_bf16 v120, v51, s33, v120
    v_dot2_f32_bf16 v121, v52, s33, v121
    v_dot2_f32_bf16 v121, v53, s33, v121
    v_dot2_f32_bf16 v121, v54, s33, v121
    v_dot2_f32_bf16 v121, v55, s33, v121
    v_dot2_f32_bf16 v124, v128, s33, v124
    v_dot2_f32_bf16 v125, v128, v128, v125
    v_dot2_f32_bf16 v124, v129, s33, v124
    v_dot2_f32_bf16 v125, v129, v129, v125
    v_dot2_f32_bf16 v124, v130, s33, v124
    v_dot2_f32_bf16 v125, v130, v130, v125
    v_dot2_f32_bf16 v124, v131, s33, v124
    v_dot2_f32_bf16 v125, v131, v131, v125
    v_dot2_f32_bf16 v124, v132, s33, v124
    v_dot2_f32_bf16 v125, v132, v132, v125
    v_dot2_f32_bf16 v124, v133, s33, v124
    v_dot2_f32_bf16 v125, v133, v133, v125
    v_dot2_f32_bf16 v124, v134, s33, v124
    v_dot2_f32_bf16 v125, v134, v134, v125
    v_dot2_f32_bf16 v124, v135, s33, v124
    v_dot2_f32_bf16 v125, v135, v135, v125
    s_waitcnt vmcnt(8)
    s_barrier
    s_add_u32 m0, s31, 32768
    s_mov_b32 s26, 384
    buffer_load_dwordx4 v10, s[36:39], s26 offen lds
    s_add_u32 m0, s31, 33792
    s_mov_b32 s26, 384
    buffer_load_dwordx4 v11, s[36:39], s26 offen lds
    s_add_u32 m0, s32, 32768
    s_mov_b32 s26, 528384
    buffer_load_dwordx4 v12, s[8:11], s26 offen lds
    s_add_u32 m0, s32, 33792
    s_mov_b32 s26, 528384
    buffer_load_dwordx4 v13, s[8:11], s26 offen lds
    ds_read_b128 v[24:27], v14 offset:49152
    ds_read_b128 v[28:31], v14 offset:51200
    ds_read_b64_tr_b16 v[32:33], v16 offset:49152
    ds_read_b64_tr_b16 v[34:35], v16 offset:50176
    ds_read_b64_tr_b16 v[36:37], v17 offset:49152
    ds_read_b64_tr_b16 v[38:39], v17 offset:50176
    ds_read_b128 v[40:43], v15 offset:49152
    ds_read_b128 v[44:47], v15 offset:51200
    ds_read_b64_tr_b16 v[48:49], v16 offset:53248
    ds_read_b64_tr_b16 v[50:51], v16 offset:54272
    ds_read_b64_tr_b16 v[52:53], v17 offset:53248
    ds_read_b64_tr_b16 v[54:55], v17 offset:54272
    ds_read_b128 v[128:131], v22 offset:49152
    ds_read_b128 v[132:135], v22 offset:49168
    s_waitcnt lgkmcnt(8)
    v_mfma_f32_32x32x16_bf16 v[56:71], v[32:35], v[24:27], v[56:71]
    v_mfma_f32_32x32x16_bf16 v[72:87], v[36:39], v[24:27], v[72:87]
    v_mfma_f32_32x32x16_bf16 v[88:103], v[32:35], v[28:31], v[88:103]
    v_mfma_f32_32x32x16_bf16 v[104:119], v[36:39], v[28:31], v[104:119]
    v_dot2_f32_bf16 v120, v32, s33, v120
    v_dot2_f32_bf16 v120, v33, s33, v120
    v_dot2_f32_bf16 v120, v34, s33, v120
    v_dot2_f32_bf16 v120, v35, s33, v120
    v_dot2_f32_bf16 v121, v36, s33, v121
    v_dot2_f32_bf16 v121, v37, s33, v121
    v_dot2_f32_bf16 v121, v38, s33, v121
    v_dot2_f32_bf16 v121, v39, s33, v121
    s_waitcnt lgkmcnt(0)
    v_mfma_f32_32x32x16_bf16 v[56:71], v[48:51], v[40:43], v[56:71]
    v_mfma_f32_32x32x16_bf16 v[72:87], v[52:55], v[40:43], v[72:87]
    v_mfma_f32_32x32x16_bf16 v[88:103], v[48:51], v[44:47], v[88:103]
    v_mfma_f32_32x32x16_bf16 v[104:119], v[52:55], v[44:47], v[104:119]
    v_dot2_f32_bf16 v120, v48, s33, v120
    v_dot2_f32_bf16 v120, v49, s33, v120
    v_dot2_f32_bf16 v120, v50, s33, v120
    v_dot2_f32_bf16 v120, v51, s33, v120
    v_dot2_f32_bf16 v121, v52, s33, v121
    v_dot2_f32_bf16 v121, v53, s33, v121
    v_dot2_f32_bf16 v121, v54, s33, v121
    v_dot2_f32_bf16 v121, v55, s33, v121
    v_dot2_f32_bf16 v124, v128, s33, v124
    v_dot2_f32_bf16 v125, v128, v128, v125
    v_dot2_f32_bf16 v124, v129, s33, v124
    v_dot2_f32_bf16 v125, v129, v129, v125
    v_dot2_f32_bf16 v124, v130, s33, v124
    v_dot2_f32_bf16 v125, v130, v130, v125
    v_dot2_f32_bf16 v124, v131, s33, v124
    v_dot2_f32_bf16 v125, v131, v131, v125
    v_dot2_f32_bf16 v124, v132, s33, v124
    v_dot2_f32_bf16 v125, v132, v132, v125
    v_dot2_f32_bf16 v124, v133, s33, v124
    v_dot2_f32_bf16 v125, v133, v133, v125
    v_dot2_f32_bf16 v124, v134, s33, v124
    v_dot2_f32_bf16 v125, v134, v134, v125
    v_dot2_f32_bf16 v124, v135, s33, v124
    v_dot2_f32_bf16 v125, v135, v135, v125
    s_waitcnt vmcnt(8)
    s_barrier
    s_add_u32 m0, s31, 49152
    s_mov_b32 s26, 448
    buffer_load_dwordx4 v10, s[36:39], s26 offen lds
    s_add_u32 m0, s31, 50176
    s_mov_b32 s26, 448
    buffer_load_dwordx4 v11, s[36:39], s26 offen lds
    s_add_u32 m0, s32, 49152
    s_mov_b32 s26, 616448
    buffer_load_dwordx4 v12, s[8:11], s26 offen lds
    s_add_u32 m0, s32, 50176
    s_mov_b32 s26, 616448
    buffer_load_dwordx4 v13, s[8:11], s26 offen lds
    ds_read_b128 v[24:27], v14 offset:0
    ds_read_b128 v[28:31], v14 offset:2048
    ds_read_b64_tr_b16 v[32:33], v16 offset:0
    ds_read_b64_tr_b16 v[34:35], v16 offset:1024
    ds_read_b64_tr_b16 v[36:37], v17 offset:0
    ds_read_b64_tr_b16 v[38:39], v17 offset:1024
    ds_read_b128 v[40:43], v15 offset:0
    ds_read_b128 v[44:47], v15 offset:2048
    ds_read_b64_tr_b16 v[48:49], v16 offset:4096
    ds_read_b64_tr_b16 v[50:51], v16 offset:5120
    ds_read_b64_tr_b16 v[52:53], v17 offset:4096
    ds_read_b64_tr_b16 v[54:55], v17 offset:5120
    ds_read_b128 v[128:131], v22 offset:0
    ds_read_b128 v[132:135], v22 offset:16
    s_waitcnt lgkmcnt(8)
    v_mfma_f32_32x32x16_bf16 v[56:71], v[32:35], v[24:27], v[56:71]
    v_mfma_f32_32x32x16_bf16 v[72:87], v[36:39], v[24:27], v[72:87]
    v_mfma_f32_32x32x16_bf16 v[88:103], v[32:35], v[28:31], v[88:103]
    v_mfma_f32_32x32x16_bf16 v[104:119], v[36:39], v[28:31], v[104:119]
    v_dot2_f32_bf16 v120, v32, s33, v120
    v_dot2_f32_bf16 v120, v33, s33, v120
    v_dot2_f32_bf16 v120, v34, s33, v120
    v_dot2_f32_bf16 v120, v35, s33, v120
    v_dot2_f32_bf16 v121, v36, s33, v121
    v_dot2_f32_bf16 v121, v37, s33, v121
    v_dot2_f32_bf16 v121, v38, s33, v121
    v_dot2_f32_bf16 v121, v39, s33, v121
    s_waitcnt lgkmcnt(0)
    v_mfma_f32_32x32x16_bf16 v[56:71], v[48:51], v[40:43], v[56:71]
    v_mfma_f32_32x32x16_bf16 v[72:87], v[52:55], v[40:43], v[72:87]
    v_mfma_f32_32x32x16_bf16 v[88:103], v[48:51], v[44:47], v[88:103]
    v_mfma_f32_32x32x16_bf16 v[104:119], v[52:55], v[44:47], v[104:119]
    v_dot2_f32_bf16 v120, v48, s33, v120
    v_dot2_f32_bf16 v120, v49, s33, v120
    v_dot2_f32_bf16 v120, v50, s33, v120
    v_dot2_f32_bf16 v120, v51, s33, v120
    v_dot2_f32_bf16 v121, v52, s33, v121
    v_dot2_f32_bf16 v121, v53, s33, v121
    v_dot2_f32_bf16 v121, v54, s33, v121
    v_dot2_f32_bf16 v121, v55, s33, v121
    v_dot2_f32_bf16 v124, v128, s33, v124
    v_dot2_f32_bf16 v125, v128, v128, v125
    v_dot2_f32_bf16 v124, v129, s33, v124
    v_dot2_f32_bf16 v125, v129, v129, v125
    v_dot2_f32_bf16 v124, v130, s33, v124
    v_dot2_f32_bf16 v125, v130, v130, v125
    v_dot2_f32_bf16 v124, v131, s33, v124
    v_dot2_f32_bf16 v125, v131, v131, v125
    v_dot2_f32_bf16 v124, v132, s33, v124
    v_dot2_f32_bf16 v125, v132, v132, v125
    v_dot2_f32_bf16 v124, v133, s33, v124
    v_dot2_f32_bf16 v125, v133, v133, v125
    v_dot2_f32_bf16 v124, v134, s33, v124
    v_dot2_f32_bf16 v125, v134, v134, v125
    v_dot2_f32_bf16 v124, v135, s33, v124
    v_dot2_f32_bf16 v125, v135, v135, v125
    s_waitcnt vmcnt(8)
    s_barrier
    s_add_u32 m0, s31, 0
    s_mov_b32 s26, 512
    buffer_load_dwordx4 v10, s[36:39], s26 offen lds
    s_add_u32 m0, s31, 1024
    s_mov_b32 s26, 512
    buffer_load_dwordx4 v11, s[36:39], s26 offen lds
    s_add_u32 m0, s32, 0
    s_mov_b32 s26, 704512
    buffer_load_dwordx4 v12, s[8:11], s26 offen lds
    s_add_u32 m0, s32, 1024
    s_mov_b32 s26, 704512
    buffer_load_dwordx4 v13, s[8:11], s26 offen lds
    ds_read_b128 v[24:27], v14 offset:16384
    ds_read_b128 v[28:31], v14 offset:18432
    ds_read_b64_tr_b16 v[32:33], v16 offset:16384
    ds_read_b64_tr_b16 v[34:35], v16 offset:17408
    ds_read_b64_tr_b16 v[36:37], v17 offset:16384
    ds_read_b64_tr_b16 v[38:39], v17 offset:17408
    ds_read_b128 v[40:43], v15 offset:16384
    ds_read_b128 v[44:47], v15 offset:18432
    ds_read_b64_tr_b16 v[48:49], v16 offset:20480
    ds_read_b64_tr_b16 v[50:51], v16 offset:21504
    ds_read_b64_tr_b16 v[52:53], v17 offset:20480
    ds_read_b64_tr_b16 v[54:55], v17 offset:21504
    ds_read_b128 v[128:131], v22 offset:16384
    ds_read_b128 v[132:135], v22 offset:16400
    s_waitcnt lgkmcnt(8)
    v_mfma_f32_32x32x16_bf16 v[56:71], v[32:35], v[24:27], v[56:71]
    v_mfma_f32_32x32x16_bf16 v[72:87], v[36:39], v[24:27], v[72:87]
    v_mfma_f32_32x32x16_bf16 v[88:103], v[32:35], v[28:31], v[88:103]
    v_mfma_f32_32x32x16_bf16 v[104:119], v[36:39], v[28:31], v[104:119]
    v_dot2_f32_bf16 v120, v32, s33, v120
    v_dot2_f32_bf16 v120, v33, s33, v120
    v_dot2_f32_bf16 v120, v34, s33, v120
    v_dot2_f32_bf16 v120, v35, s33, v120
    v_dot2_f32_bf16 v121, v36, s33, v121
    v_dot2_f32_bf16 v121, v37, s33, v121
    v_dot2_f32_bf16 v121, v38, s33, v121
    v_dot2_f32_bf16 v121, v39, s33, v121
    s_waitcnt lgkmcnt(0)
    v_mfma_f32_32x32x16_bf16 v[56:71], v[48:51], v[40:43], v[56:71]
    v_mfma_f32_32x32x16_bf16 v[72:87], v[52:55], v[40:43], v[72:87]
    v_mfma_f32_32x32x16_bf16 v[88:103], v[48:51], v[44:47], v[88:103]
    v_mfma_f32_32x32x16_bf16 v[104:119], v[52:55], v[44:47], v[104:119]
    v_dot2_f32_bf16 v120, v48, s33, v120
    v_dot2_f32_bf16 v120, v49, s33, v120
    v_dot2_f32_bf16 v120, v50, s33, v120
    v_dot2_f32_bf16 v120, v51, s33, v120
    v_dot2_f32_bf16 v121, v52, s33, v121
    v_dot2_f32_bf16 v121, v53, s33, v121
    v_dot2_f32_bf16 v121, v54, s33, v121
    v_dot2_f32_bf16 v121, v55, s33, v121
    v_dot2_f32_bf16 v124, v128, s33, v124
    v_dot2_f32_bf16 v125, v128, v128, v125
    v_dot2_f32_bf16 v124, v129, s33, v124
    v_dot2_f32_bf16 v125, v129, v129, v125
    v_dot2_f32_bf16 v124, v130, s33, v124
    v_dot2_f32_bf16 v125, v130, v130, v125
    v_dot2_f32_bf16 v124, v131, s33, v124
    v_dot2_f32_bf16 v125, v131, v131, v125
    v_dot2_f32_bf16 v124, v132, s33, v124
    v_dot2_f32_bf16 v125, v132, v132, v125
    v_dot2_f32_bf16 v124, v133, s33, v124
    v_dot2_f32_bf16 v125, v133, v133, v125
    v_dot2_f32_bf16 v124, v134, s33, v124
    v_dot2_f32_bf16 v125, v134, v134, v125
    v_dot2_f32_bf16 v124, v135, s33, v124
    v_dot2_f32_bf16 v125, v135, v135, v125
    s_waitcnt vmcnt(8)
    s_barrier
    s_add_u32 m0, s31, 16384
    s_mov_b32 s26, 576
    buffer_load_dwordx4 v10, s[36:39], s26 offen lds
    s_add_u32 m0, s31, 17408
    s_mov_b32 s26, 576
    buffer_load_dwordx4 v11, s[36:39], s26 offen lds
    s_add_u32 m0, s32, 16384
    s_mov_b32 s26, 792576
    buffer_load_dwordx4 v12, s[8:11], s26 offen lds
    s_add_u32 m0, s32, 17408
    s_mov_b32 s26, 792576
    buffer_load_dwordx4 v13, s[8:11], s26 offen lds
    ds_read_b128 v[24:27], v14 offset:32768
    ds_read_b128 v[28:31], v14 offset:34816
    ds_read_b64_tr_b16 v[32:33], v16 offset:32768
    ds_read_b64_tr_b16 v[34:35], v16 offset:33792
    ds_read_b64_tr_b16 v[36:37], v17 offset:32768
    ds_read_b64_tr_b16 v[38:39], v17 offset:33792
    ds_read_b128 v[40:43], v15 offset:32768
    ds_read_b128 v[44:47], v15 offset:34816
    ds_read_b64_tr_b16 v[48:49], v16 offset:36864
    ds_read_b64_tr_b16 v[50:51], v16 offset:37888
    ds_read_b64_tr_b16 v[52:53], v17 offset:36864
    ds_read_b64_tr_b16 v[54:55], v17 offset:37888
    ds_read_b128 v[128:131], v22 offset:32768
    ds_read_b128 v[132:135], v22 offset:32784
    s_waitcnt lgkmcnt(8)
    v_mfma_f32_32x32x16_bf16 v[56:71], v[32:35], v[24:27], v[56:71]
    v_mfma_f32_32x32x16_bf16 v[72:87], v[36:39], v[24:27], v[72:87]
    v_mfma_f32_32x32x16_bf16 v[88:103], v[32:35], v[28:31], v[88:103]
    v_mfma_f32_32x32x16_bf16 v[104:119], v[36:39], v[28:31], v[104:119]
    v_dot2_f32_bf16 v120, v32, s33, v120
    v_dot2_f32_bf16 v120, v33, s33, v120
    v_dot2_f32_bf16 v120, v34, s33, v120
    v_dot2_f32_bf16 v120, v35, s33, v120
    v_dot2_f32_bf16 v121, v36, s33, v121
    v_dot2_f32_bf16 v121, v37, s33, v121
    v_dot2_f32_bf16 v121, v38, s33, v121
    v_dot2_f32_bf16 v121, v39, s33, v121
    s_waitcnt lgkmcnt(0)
    v_mfma_f32_32x32x16_bf16 v[56:71], v[48:51], v[40:43], v[56:71]
    v_mfma_f32_32x32x16_bf16 v[72:87], v[52:55], v[40:43], v[72:87]
    v_mfma_f32_32x32x16_bf16 v[88:103], v[48:51], v[44:47], v[88:103]
    v_mfma_f32_32x32x16_bf16 v[104:119], v[52:55], v[44:47], v[104:119]
    v_dot2_f32_bf16 v120, v48, s33, v120
    v_dot2_f32_bf16 v120, v49, s33, v120
    v_dot2_f32_bf16 v120, v50, s33, v120
    v_dot2_f32_bf16 v120, v51, s33, v120
    v_dot2_f32_bf16 v121, v52, s33, v121
    v_dot2_f32_bf16 v121, v53, s33, v121
    v_dot2_f32_bf16 v121, v54, s33, v121
    v_dot2_f32_bf16 v121, v55, s33, v121
    v_dot2_f32_bf16 v124, v128, s33, v124
    v_dot2_f32_bf16 v125, v128, v128, v125
    v_dot2_f32_bf16 v124, v129, s33, v124
    v_dot2_f32_bf16 v125, v129, v129, v125
    v_dot2_f32_bf16 v124, v130, s33, v124
    v_dot2_f32_bf16 v125, v130, v130, v125
    v_dot2_f32_bf16 v124, v131, s33, v124
    v_dot2_f32_bf16 v125, v131, v131, v125
    v_dot2_f32_bf16 v124, v132, s33, v124
    v_dot2_f32_bf16 v125, v132, v132, v125
    v_dot2_f32_bf16 v124, v133, s33, v124
    v_dot2_f32_bf16 v125, v133, v133, v125
    v_dot2_f32_bf16 v124, v134, s33, v124
    v_dot2_f32_bf16 v125, v134, v134, v125
    v_dot2_f32_bf16 v124, v135, s33, v124
    v_dot2_f32_bf16 v125, v135, v135, v125
    s_waitcnt vmcnt(8)
    s_barrier
    s_add_u32 m0, s31, 32768
    s_mov_b32 s26, 640
    buffer_load_dwordx4 v10, s[36:39], s26 offen lds
    s_add_u32 m0, s31, 33792
    s_mov_b32 s26, 640
    buffer_load_dwordx4 v11, s[36:39], s26 offen lds
    s_add_u32 m0, s32, 32768
    s_mov_b32 s26, 880640
    buffer_load_dwordx4 v12, s[8:11], s26 offen lds
    s_add_u32 m0, s32, 33792
    s_mov_b32 s26, 880640
    buffer_load_dwordx4 v13, s[8:11], s26 offen lds
    ds_read_b128 v[24:27], v14 offset:49152
    ds_read_b128 v[28:31], v14 offset:51200
    ds_read_b64_tr_b16 v[32:33], v16 offset:49152
    ds_read_b64_tr_b16 v[34:35], v16 offset:50176
    ds_read_b64_tr_b16 v[36:37], v17 offset:49152
    ds_read_b64_tr_b16 v[38:39], v17 offset:50176
    ds_read_b128 v[40:43], v15 offset:49152
    ds_read_b128 v[44:47], v15 offset:51200
    ds_read_b64_tr_b16 v[48:49], v16 offset:53248
    ds_read_b64_tr_b16 v[50:51], v16 offset:54272
    ds_read_b64_tr_b16 v[52:53], v17 offset:53248
    ds_read_b64_tr_b16 v[54:55], v17 offset:54272
    ds_read_b128 v[128:131], v22 offset:49152
    ds_read_b128 v[132:135], v22 offset:49168
    s_waitcnt lgkmcnt(8)
    v_mfma_f32_32x32x16_bf16 v[56:71], v[32:35], v[24:27], v[56:71]
    v_mfma_f32_32x32x16_bf16 v[72:87], v[36:39], v[24:27], v[72:87]
    v_mfma_f32_32x32x16_bf16 v[88:103], v[32:35], v[28:31], v[88:103]
    v_mfma_f32_32x32x16_bf16 v[104:119], v[36:39], v[28:31], v[104:119]
    v_dot2_f32_bf16 v120, v32, s33, v120
    v_dot2_f32_bf16 v120, v33, s33, v120
    v_dot2_f32_bf16 v120, v34, s33, v120
    v_dot2_f32_bf16 v120, v35, s33, v120
    v_dot2_f32_bf16 v121, v36, s33, v121
    v_dot2_f32_bf16 v121, v37, s33, v121
    v_dot2_f32_bf16 v121, v38, s33, v121
    v_dot2_f32_bf16 v121, v39, s33, v121
    s_waitcnt lgkmcnt(0)
    v_mfma_f32_32x32x16_bf16 v[56:71], v[48:51], v[40:43], v[56:71]
    v_mfma_f32_32x32x16_bf16 v[72:87], v[52:55], v[40:43], v[72:87]
    v_mfma_f32_32x32x16_bf16 v[88:103], v[48:51], v[44:47], v[88:103]
    v_mfma_f32_32x32x16_bf16 v[104:119], v[52:55], v[44:47], v[104:119]
    v_dot2_f32_bf16 v120, v48, s33, v120
    v_dot2_f32_bf16 v120, v49, s33, v120
    v_dot2_f32_bf16 v120, v50, s33, v120
    v_dot2_f32_bf16 v120, v51, s33, v120
    v_dot2_f32_bf16 v121, v52, s33, v121
    v_dot2_f32_bf16 v121, v53, s33, v121
    v_dot2_f32_bf16 v121, v54, s33, v121
    v_dot2_f32_bf16 v121, v55, s33, v121
    v_dot2_f32_bf16 v124, v128, s33, v124
    v_dot2_f32_bf16 v125, v128, v128, v125
    v_dot2_f32_bf16 v124, v129, s33, v124
    v_dot2_f32_bf16 v125, v129, v129, v125
    v_dot2_f32_bf16 v124, v130, s33, v124
    v_dot2_f32_bf16 v125, v130, v130, v125
    v_dot2_f32_bf16 v124, v131, s33, v124
    v_dot2_f32_bf16 v125, v131, v131, v125
    v_dot2_f32_bf16 v124, v132, s33, v124
    v_dot2_f32_bf16 v125, v132, v132, v125
    v_dot2_f32_bf16 v124, v133, s33, v124
    v_dot2_f32_bf16 v125, v133, v133, v125
    v_dot2_f32_bf16 v124, v134, s33, v124
    v_dot2_f32_bf16 v125, v134, v134, v125
    v_dot2_f32_bf16 v124, v135, s33, v124
    v_dot2_f32_bf16 v125, v135, v135, v125
    s_waitcnt vmcnt(8)
    s_barrier
    s_add_u32 m0, s31, 49152
    s_mov_b32 s26, 704
    buffer_load_dwordx4 v10, s[36:39], s26 offen lds
    s_add_u32 m0, s31, 50176
    s_mov_b32 s26, 704
    buffer_load_dwordx4 v11, s[36:39], s26 offen lds
    s_add_u32 m0, s32, 49152
    s_mov_b32 s26, 968704
    buffer_load_dwordx4 v12, s[8:11], s26 offen lds
    s_add_u32 m0, s32, 50176
    s_mov_b32 s26, 968704
    buffer_load_dwordx4 v13, s[8:11], s26 offen lds
    ds_read_b128 v[24:27], v14 offset:0
    ds_read_b128 v[28:31], v14 offset:2048
    ds_read_b64_tr_b16 v[32:33], v16 offset:0
    ds_read_b64_tr_b16 v[34:35], v16 offset:1024
    ds_read_b64_tr_b16 v[36:37], v17 offset:0
    ds_read_b64_tr_b16 v[38:39], v17 offset:1024
    ds_read_b128 v[40:43], v15 offset:0
    ds_read_b128 v[44:47], v15 offset:2048
    ds_read_b64_tr_b16 v[48:49], v16 offset:4096
    ds_read_b64_tr_b16 v[50:51], v16 offset:5120
    ds_read_b64_tr_b16 v[52:53], v17 offset:4096
    ds_read_b64_tr_b16 v[54:55], v17 offset:5120
    ds_read_b128 v[128:131], v22 offset:0
    ds_read_b128 v[132:135], v22 offset:16
    s_waitcnt lgkmcnt(8)
    v_mfma_f32_32x32x16_bf16 v[56:71], v[32:35], v[24:27], v[56:71]
    v_mfma_f32_32x32x16_bf16 v[72:87], v[36:39], v[24:27], v[72:87]
    v_mfma_f32_32x32x16_bf16 v[88:103], v[32:35], v[28:31], v[88:103]
    v_mfma_f32_32x32x16_bf16 v[104:119], v[36:39], v[28:31], v[104:119]
    v_dot2_f32_bf16 v120, v32, s33, v120
    v_dot2_f32_bf16 v120, v33, s33, v120
    v_dot2_f32_bf16 v120, v34, s33, v120
    v_dot2_f32_bf16 v120, v35, s33, v120
    v_dot2_f32_bf16 v121, v36, s33, v121
    v_dot2_f32_bf16 v121, v37, s33, v121
    v_dot2_f32_bf16 v121, v38, s33, v121
    v_dot2_f32_bf16 v121, v39, s33, v121
    s_waitcnt lgkmcnt(0)
    v_mfma_f32_32x32x16_bf16 v[56:71], v[48:51], v[40:43], v[56:71]
    v_mfma_f32_32x32x16_bf16 v[72:87], v[52:55], v[40:43], v[72:87]
    v_mfma_f32_32x32x16_bf16 v[88:103], v[48:51], v[44:47], v[88:103]
    v_mfma_f32_32x32x16_bf16 v[104:119], v[52:55], v[44:47], v[104:119]
    v_dot2_f32_bf16 v120, v48, s33, v120
    v_dot2_f32_bf16 v120, v49, s33, v120
    v_dot2_f32_bf16 v120, v50, s33, v120
    v_dot2_f32_bf16 v120, v51, s33, v120
    v_dot2_f32_bf16 v121, v52, s33, v121
    v_dot2_f32_bf16 v121, v53, s33, v121
    v_dot2_f32_bf16 v121, v54, s33, v121
    v_dot2_f32_bf16 v121, v55, s33, v121
    v_dot2_f32_bf16 v124, v128, s33, v124
    v_dot2_f32_bf16 v125, v128, v128, v125
    v_dot2_f32_bf16 v124, v129, s33, v124
    v_dot2_f32_bf16 v125, v129, v129, v125
    v_dot2_f32_bf16 v124, v130, s33, v124
    v_dot2_f32_bf16 v125, v130, v130, v125
    v_dot2_f32_bf16 v124, v131, s33, v124
    v_dot2_f32_bf16 v125, v131, v131, v125
    v_dot2_f32_bf16 v124, v132, s33, v124
    v_dot2_f32_bf16 v125, v132, v132, v125
    v_dot2_f32_bf16 v124, v133, s33, v124
    v_dot2_f32_bf16 v125, v133, v133, v125
    v_dot2_f32_bf16 v124, v134, s33, v124
    v_dot2_f32_bf16 v125, v134, v134, v125
    v_dot2_f32_bf16 v124, v135, s33, v124
    v_dot2_f32_bf16 v125, v135, v135, v125
    s_waitcnt vmcnt(8)
    s_barrier
    s_add_u32 m0, s31, 0
    s_mov_b32 s26, 768
    buffer_load_dwordx4 v10, s[36:39], s26 offen lds
    s_add_u32 m0, s31, 1024
    s_mov_b32 s26, 768
    buffer_load_dwordx4 v11, s[36:39], s26 offen lds
    s_add_u32 m0, s32, 0
    s_mov_b32 s26, 1056768
    buffer_load_dwordx4 v12, s[8:11], s26 offen lds
    s_add_u32 m0, s32, 1024
    s_mov_b32 s26, 1056768
    buffer_load_dwordx4 v13, s[8:11], s26 offen lds
    ds_read_b128 v[24:27], v14 offset:16384
    ds_read_b128 v[28:31], v14 offset:18432
    ds_read_b64_tr_b16 v[32:33], v16 offset:16384
    ds_read_b64_tr_b16 v[34:35], v16 offset:17408
    ds_read_b64_tr_b16 v[36:37], v17 offset:16384
    ds_read_b64_tr_b16 v[38:39], v17 offset:17408
    ds_read_b128 v[40:43], v15 offset:16384
    ds_read_b128 v[44:47], v15 offset:18432
    ds_read_b64_tr_b16 v[48:49], v16 offset:20480
    ds_read_b64_tr_b16 v[50:51], v16 offset:21504
    ds_read_b64_tr_b16 v[52:53], v17 offset:20480
    ds_read_b64_tr_b16 v[54:55], v17 offset:21504
    ds_read_b128 v[128:131], v22 offset:16384
    ds_read_b128 v[132:135], v22 offset:16400
    s_waitcnt lgkmcnt(8)
    v_mfma_f32_32x32x16_bf16 v[56:71], v[32:35], v[24:27], v[56:71]
    v_mfma_f32_32x32x16_bf16 v[72:87], v[36:39], v[24:27], v[72:87]
    v_mfma_f32_32x32x16_bf16 v[88:103], v[32:35], v[28:31], v[88:103]
    v_mfma_f32_32x32x16_bf16 v[104:119], v[36:39], v[28:31], v[104:119]
    v_dot2_f32_bf16 v120, v32, s33, v120
    v_dot2_f32_bf16 v120, v33, s33, v120
    v_dot2_f32_bf16 v120, v34, s33, v120
    v_dot2_f32_bf16 v120, v35, s33, v120
    v_dot2_f32_bf16 v121, v36, s33, v121
    v_dot2_f32_bf16 v121, v37, s33, v121
    v_dot2_f32_bf16 v121, v38, s33, v121
    v_dot2_f32_bf16 v121, v39, s33, v121
    s_waitcnt lgkmcnt(0)
    v_mfma_f32_32x32x16_bf16 v[56:71], v[48:51], v[40:43], v[56:71]
    v_mfma_f32_32x32x16_bf16 v[72:87], v[52:55], v[40:43], v[72:87]
    v_mfma_f32_32x32x16_bf16 v[88:103], v[48:51], v[44:47], v[88:103]
    v_mfma_f32_32x32x16_bf16 v[104:119], v[52:55], v[44:47], v[104:119]
    v_dot2_f32_bf16 v120, v48, s33, v120
    v_dot2_f32_bf16 v120, v49, s33, v120
    v_dot2_f32_bf16 v120, v50, s33, v120
    v_dot2_f32_bf16 v120, v51, s33, v120
    v_dot2_f32_bf16 v121, v52, s33, v121
    v_dot2_f32_bf16 v121, v53, s33, v121
    v_dot2_f32_bf16 v121, v54, s33, v121
    v_dot2_f32_bf16 v121, v55, s33, v121
    v_dot2_f32_bf16 v124, v128, s33, v124
    v_dot2_f32_bf16 v125, v128, v128, v125
    v_dot2_f32_bf16 v124, v129, s33, v124
    v_dot2_f32_bf16 v125, v129, v129, v125
    v_dot2_f32_bf16 v124, v130, s33, v124
    v_dot2_f32_bf16 v125, v130, v130, v125
    v_dot2_f32_bf16 v124, v131, s33, v124
    v_dot2_f32_bf16 v125, v131, v131, v125
    v_dot2_f32_bf16 v124, v132, s33, v124
    v_dot2_f32_bf16 v125, v132, v132, v125
    v_dot2_f32_bf16 v124, v133, s33, v124
    v_dot2_f32_bf16 v125, v133, v133, v125
    v_dot2_f32_bf16 v124, v134, s33, v124
    v_dot2_f32_bf16 v125, v134, v134, v125
    v_dot2_f32_bf16 v124, v135, s33, v124
    v_dot2_f32_bf16 v125, v135, v135, v125
    s_waitcnt vmcnt(8)
    s_barrier
    s_add_u32 m0, s31, 16384
    s_mov_b32 s26, 832
    buffer_load_dwordx4 v10, s[36:39], s26 offen lds
    s_add_u32 m0, s31, 17408
    s_mov_b32 s26, 832
    buffer_load_dwordx4 v11, s[36:39], s26 offen lds
    s_add_u32 m0, s32, 16384
    s_mov_b32 s26, 1144832
    buffer_load_dwordx4 v12, s[8:11], s26 offen lds
    s_add_u32 m0, s32, 17408
    s_mov_b32 s26, 1144832
    buffer_load_dwordx4 v13, s[8:11], s26 offen lds
    ds_read_b128 v[24:27], v14 offset:32768
    ds_read_b128 v[28:31], v14 offset:34816
    ds_read_b64_tr_b16 v[32:33], v16 offset:32768
    ds_read_b64_tr_b16 v[34:35], v16 offset:33792
    ds_read_b64_tr_b16 v[36:37], v17 offset:32768
    ds_read_b64_tr_b16 v[38:39], v17 offset:33792
    ds_read_b128 v[40:43], v15 offset:32768
    ds_read_b128 v[44:47], v15 offset:34816
    ds_read_b64_tr_b16 v[48:49], v16 offset:36864
    ds_read_b64_tr_b16 v[50:51], v16 offset:37888
    ds_read_b64_tr_b16 v[52:53], v17 offset:36864
    ds_read_b64_tr_b16 v[54:55], v17 offset:37888
    ds_read_b128 v[128:131], v22 offset:32768
    ds_read_b128 v[132:135], v22 offset:32784
    s_waitcnt lgkmcnt(8)
    v_mfma_f32_32x32x16_bf16 v[56:71], v[32:35], v[24:27], v[56:71]
    v_mfma_f32_32x32x16_bf16 v[72:87], v[36:39], v[24:27], v[72:87]
    v_mfma_f32_32x32x16_bf16 v[88:103], v[32:35], v[28:31], v[88:103]
    v_mfma_f32_32x32x16_bf16 v[104:119], v[36:39], v[28:31], v[104:119]
    v_dot2_f32_bf16 v120, v32, s33, v120
    v_dot2_f32_bf16 v120, v33, s33, v120
    v_dot2_f32_bf16 v120, v34, s33, v120
    v_dot2_f32_bf16 v120, v35, s33, v120
    v_dot2_f32_bf16 v121, v36, s33, v121
    v_dot2_f32_bf16 v121, v37, s33, v121
    v_dot2_f32_bf16 v121, v38, s33, v121
    v_dot2_f32_bf16 v121, v39, s33, v121
    s_waitcnt lgkmcnt(0)
    v_mfma_f32_32x32x16_bf16 v[56:71], v[48:51], v[40:43], v[56:71]
    v_mfma_f32_32x32x16_bf16 v[72:87], v[52:55], v[40:43], v[72:87]
    v_mfma_f32_32x32x16_bf16 v[88:103], v[48:51], v[44:47], v[88:103]
    v_mfma_f32_32x32x16_bf16 v[104:119], v[52:55], v[44:47], v[104:119]
    v_dot2_f32_bf16 v120, v48, s33, v120
    v_dot2_f32_bf16 v120, v49, s33, v120
    v_dot2_f32_bf16 v120, v50, s33, v120
    v_dot2_f32_bf16 v120, v51, s33, v120
    v_dot2_f32_bf16 v121, v52, s33, v121
    v_dot2_f32_bf16 v121, v53, s33, v121
    v_dot2_f32_bf16 v121, v54, s33, v121
    v_dot2_f32_bf16 v121, v55, s33, v121
    v_dot2_f32_bf16 v124, v128, s33, v124
    v_dot2_f32_bf16 v125, v128, v128, v125
    v_dot2_f32_bf16 v124, v129, s33, v124
    v_dot2_f32_bf16 v125, v129, v129, v125
    v_dot2_f32_bf16 v124, v130, s33, v124
    v_dot2_f32_bf16 v125, v130, v130, v125
    v_dot2_f32_bf16 v124, v131, s33, v124
    v_dot2_f32_bf16 v125, v131, v131, v125
    v_dot2_f32_bf16 v124, v132, s33, v124
    v_dot2_f32_bf16 v125, v132, v132, v125
    v_dot2_f32_bf16 v124, v133, s33, v124
    v_dot2_f32_bf16 v125, v133, v133, v125
    v_dot2_f32_bf16 v124, v134, s33, v124
    v_dot2_f32_bf16 v125, v134, v134, v125
    v_dot2_f32_bf16 v124, v135, s33, v124
    v_dot2_f32_bf16 v125, v135, v135, v125
    s_waitcnt vmcnt(8)
    s_barrier
    s_add_u32 m0, s31, 32768
    s_mov_b32 s26, 896
    buffer_load_dwordx4 v10, s[36:39], s26 offen lds
    s_add_u32 m0, s31, 33792
    s_mov_b32 s26, 896
    buffer_load_dwordx4 v11, s[36:39], s26 offen lds
    s_add_u32 m0, s32, 32768
    s_mov_b32 s26, 1232896
    buffer_load_dwordx4 v12, s[8:11], s26 offen lds
    s_add_u32 m0, s32, 33792
    s_mov_b32 s26, 1232896
    buffer_load_dwordx4 v13, s[8:11], s26 offen lds
    ds_read_b128 v[24:27], v14 offset:49152
    ds_read_b128 v[28:31], v14 offset:51200
    ds_read_b64_tr_b16 v[32:33], v16 offset:49152
    ds_read_b64_tr_b16 v[34:35], v16 offset:50176
    ds_read_b64_tr_b16 v[36:37], v17 offset:49152
    ds_read_b64_tr_b16 v[38:39], v17 offset:50176
    ds_read_b128 v[40:43], v15 offset:49152
    ds_read_b128 v[44:47], v15 offset:51200
    ds_read_b64_tr_b16 v[48:49], v16 offset:53248
    ds_read_b64_tr_b16 v[50:51], v16 offset:54272
    ds_read_b64_tr_b16 v[52:53], v17 offset:53248
    ds_read_b64_tr_b16 v[54:55], v17 offset:54272
    ds_read_b128 v[128:131], v22 offset:49152
    ds_read_b128 v[132:135], v22 offset:49168
    s_waitcnt lgkmcnt(8)
    v_mfma_f32_32x32x16_bf16 v[56:71], v[32:35], v[24:27], v[56:71]
    v_mfma_f32_32x32x16_bf16 v[72:87], v[36:39], v[24:27], v[72:87]
    v_mfma_f32_32x32x16_bf16 v[88:103], v[32:35], v[28:31], v[88:103]
    v_mfma_f32_32x32x16_bf16 v[104:119], v[36:39], v[28:31], v[104:119]
    v_dot2_f32_bf16 v120, v32, s33, v120
    v_dot2_f32_bf16 v120, v33, s33, v120
    v_dot2_f32_bf16 v120, v34, s33, v120
    v_dot2_f32_bf16 v120, v35, s33, v120
    v_dot2_f32_bf16 v121, v36, s33, v121
    v_dot2_f32_bf16 v121, v37, s33, v121
    v_dot2_f32_bf16 v121, v38, s33, v121
    v_dot2_f32_bf16 v121, v39, s33, v121
    s_waitcnt lgkmcnt(0)
    v_mfma_f32_32x32x16_bf16 v[56:71], v[48:51], v[40:43], v[56:71]
    v_mfma_f32_32x32x16_bf16 v[72:87], v[52:55], v[40:43], v[72:87]
    v_mfma_f32_32x32x16_bf16 v[88:103], v[48:51], v[44:47], v[88:103]
    v_mfma_f32_32x32x16_bf16 v[104:119], v[52:55], v[44:47], v[104:119]
    v_dot2_f32_bf16 v120, v48, s33, v120
    v_dot2_f32_bf16 v120, v49, s33, v120
    v_dot2_f32_bf16 v120, v50, s33, v120
    v_dot2_f32_bf16 v120, v51, s33, v120
    v_dot2_f32_bf16 v121, v52, s33, v121
    v_dot2_f32_bf16 v121, v53, s33, v121
    v_dot2_f32_bf16 v121, v54, s33, v121
    v_dot2_f32_bf16 v121, v55, s33, v121
    v_dot2_f32_bf16 v124, v128, s33, v124
    v_dot2_f32_bf16 v125, v128, v128, v125
    v_dot2_f32_bf16 v124, v129, s33, v124
    v_dot2_f32_bf16 v125, v129, v129, v125
    v_dot2_f32_bf16 v124, v130, s33, v124
    v_dot2_f32_bf16 v125, v130, v130, v125
    v_dot2_f32_bf16 v124, v131, s33, v124
    v_dot2_f32_bf16 v125, v131, v131, v125
    v_dot2_f32_bf16 v124, v132, s33, v124
    v_dot2_f32_bf16 v125, v132, v132, v125
    v_dot2_f32_bf16 v124, v133, s33, v124
    v_dot2_f32_bf16 v125, v133, v133, v125
    v_dot2_f32_bf16 v124, v134, s33, v124
    v_dot2_f32_bf16 v125, v134, v134, v125
    v_dot2_f32_bf16 v124, v135, s33, v124
    v_dot2_f32_bf16 v125, v135, v135, v125
    s_waitcnt vmcnt(8)
    s_barrier
    s_add_u32 m0, s31, 49152
    s_mov_b32 s26, 960
    buffer_load_dwordx4 v10, s[36:39], s26 offen lds
    s_add_u32 m0, s31, 50176
    s_mov_b32 s26, 960
    buffer_load_dwordx4 v11, s[36:39], s26 offen lds
    s_add_u32 m0, s32, 49152
    s_mov_b32 s26, 1320960
    buffer_load_dwordx4 v12, s[8:11], s26 offen lds
    s_add_u32 m0, s32, 50176
    s_mov_b32 s26, 1320960
    buffer_load_dwordx4 v13, s[8:11], s26 offen lds
    ds_read_b128 v[24:27], v14 offset:0
    ds_read_b128 v[28:31], v14 offset:2048
    ds_read_b64_tr_b16 v[32:33], v16 offset:0
    ds_read_b64_tr_b16 v[34:35], v16 offset:1024
    ds_read_b64_tr_b16 v[36:37], v17 offset:0
    ds_read_b64_tr_b16 v[38:39], v17 offset:1024
    ds_read_b128 v[40:43], v15 offset:0
    ds_read_b128 v[44:47], v15 offset:2048
    ds_read_b64_tr_b16 v[48:49], v16 offset:4096
    ds_read_b64_tr_b16 v[50:51], v16 offset:5120
    ds_read_b64_tr_b16 v[52:53], v17 offset:4096
    ds_read_b64_tr_b16 v[54:55], v17 offset:5120
    ds_read_b128 v[128:131], v22 offset:0
    ds_read_b128 v[132:135], v22 offset:16
    s_waitcnt lgkmcnt(8)
    v_mfma_f32_32x32x16_bf16 v[56:71], v[32:35], v[24:27], v[56:71]
    v_mfma_f32_32x32x16_bf16 v[72:87], v[36:39], v[24:27], v[72:87]
    v_mfma_f32_32x32x16_bf16 v[88:103], v[32:35], v[28:31], v[88:103]
    v_mfma_f32_32x32x16_bf16 v[104:119], v[36:39], v[28:31], v[104:119]
    v_dot2_f32_bf16 v120, v32, s33, v120
    v_dot2_f32_bf16 v120, v33, s33, v120
    v_dot2_f32_bf16 v120, v34, s33, v120
    v_dot2_f32_bf16 v120, v35, s33, v120
    v_dot2_f32_bf16 v121, v36, s33, v121
    v_dot2_f32_bf16 v121, v37, s33, v121
    v_dot2_f32_bf16 v121, v38, s33, v121
    v_dot2_f32_bf16 v121, v39, s33, v121
    s_waitcnt lgkmcnt(0)
    v_mfma_f32_32x32x16_bf16 v[56:71], v[48:51], v[40:43], v[56:71]
    v_mfma_f32_32x32x16_bf16 v[72:87], v[52:55], v[40:43], v[72:87]
    v_mfma_f32_32x32x16_bf16 v[88:103], v[48:51], v[44:47], v[88:103]
    v_mfma_f32_32x32x16_bf16 v[104:119], v[52:55], v[44:47], v[104:119]
    v_dot2_f32_bf16 v120, v48, s33, v120
    v_dot2_f32_bf16 v120, v49, s33, v120
    v_dot2_f32_bf16 v120, v50, s33, v120
    v_dot2_f32_bf16 v120, v51, s33, v120
    v_dot2_f32_bf16 v121, v52, s33, v121
    v_dot2_f32_bf16 v121, v53, s33, v121
    v_dot2_f32_bf16 v121, v54, s33, v121
    v_dot2_f32_bf16 v121, v55, s33, v121
    v_dot2_f32_bf16 v124, v128, s33, v124
    v_dot2_f32_bf16 v125, v128, v128, v125
    v_dot2_f32_bf16 v124, v129, s33, v124
    v_dot2_f32_bf16 v125, v129, v129, v125
    v_dot2_f32_bf16 v124, v130, s33, v124
    v_dot2_f32_bf16 v125, v130, v130, v125
    v_dot2_f32_bf16 v124, v131, s33, v124
    v_dot2_f32_bf16 v125, v131, v131, v125
    v_dot2_f32_bf16 v124, v132, s33, v124
    v_dot2_f32_bf16 v125, v132, v132, v125
    v_dot2_f32_bf16 v124, v133, s33, v124
    v_dot2_f32_bf16 v125, v133, v133, v125
    v_dot2_f32_bf16 v124, v134, s33, v124
    v_dot2_f32_bf16 v125, v134, v134, v125
    v_dot2_f32_bf16 v124, v135, s33, v124
    v_dot2_f32_bf16 v125, v135, v135, v125
    s_waitcnt vmcnt(8)
    s_barrier
    ds_read_b128 v[24:27], v14 offset:16384
    ds_read_b128 v[28:31], v14 offset:18432
    ds_read_b64_tr_b16 v[32:33], v16 offset:16384
    ds_read_b64_tr_b16 v[34:35], v16 offset:17408
    ds_read_b64_tr_b16 v[36:37], v17 offset:16384
    ds_read_b64_tr_b16 v[38:39], v17 offset:17408
    ds_read_b128 v[40:43], v15 offset:16384
    ds_read_b128 v[44:47], v15 offset:18432
    ds_read_b64_tr_b16 v[48:49], v16 offset:20480
    ds_read_b64_tr_b16 v[50:51], v16 offset:21504
    ds_read_b64_tr_b16 v[52:53], v17 offset:20480
    ds_read_b64_tr_b16 v[54:55], v17 offset:21504
    ds_read_b128 v[128:131], v22 offset:16384
    ds_read_b128 v[132:135], v22 offset:16400
    s_waitcnt lgkmcnt(8)
    v_mfma_f32_32x32x16_bf16 v[56:71], v[32:35], v[24:27], v[56:71]
    v_mfma_f32_32x32x16_bf16 v[72:87], v[36:39], v[24:27], v[72:87]
    v_mfma_f32_32x32x16_bf16 v[88:103], v[32:35], v[28:31], v[88:103]
    v_mfma_f32_32x32x16_bf16 v[104:119], v[36:39], v[28:31], v[104:119]
    v_dot2_f32_bf16 v120, v32, s33, v120
    v_dot2_f32_bf16 v120, v33, s33, v120
    v_dot2_f32_bf16 v120, v34, s33, v120
    v_dot2_f32_bf16 v120, v35, s33, v120
    v_dot2_f32_bf16 v121, v36, s33, v121
    v_dot2_f32_bf16 v121, v37, s33, v121
    v_dot2_f32_bf16 v121, v38, s33, v121
    v_dot2_f32_bf16 v121, v39, s33, v121
    s_waitcnt lgkmcnt(0)
    v_mfma_f32_32x32x16_bf16 v[56:71], v[48:51], v[40:43], v[56:71]
    v_mfma_f32_32x32x16_bf16 v[72:87], v[52:55], v[40:43], v[72:87]
    v_mfma_f32_32x32x16_bf16 v[88:103], v[48:51], v[44:47], v[88:103]
    v_mfma_f32_32x32x16_bf16 v[104:119], v[52:55], v[44:47], v[104:119]
    v_dot2_f32_bf16 v120, v48, s33, v120
    v_dot2_f32_bf16 v120, v49, s33, v120
    v_dot2_f32_bf16 v120, v50, s33, v120
    v_dot2_f32_bf16 v120, v51, s33, v120
    v_dot2_f32_bf16 v121, v52, s33, v121
    v_dot2_f32_bf16 v121, v53, s33, v121
    v_dot2_f32_bf16 v121, v54, s33, v121
    v_dot2_f32_bf16 v121, v55, s33, v121
    v_dot2_f32_bf16 v124, v128, s33, v124
    v_dot2_f32_bf16 v125, v128, v128, v125
    v_dot2_f32_bf16 v124, v129, s33, v124
    v_dot2_f32_bf16 v125, v129, v129, v125
    v_dot2_f32_bf16 v124, v130, s33, v124
    v_dot2_f32_bf16 v125, v130, v130, v125
    v_dot2_f32_bf16 v124, v131, s33, v124
    v_dot2_f32_bf16 v125, v131, v131, v125
    v_dot2_f32_bf16 v124, v132, s33, v124
    v_dot2_f32_bf16 v125, v132, v132, v125
    v_dot2_f32_bf16 v124, v133, s33, v124
    v_dot2_f32_bf16 v125, v133, v133, v125
    v_dot2_f32_bf16 v124, v134, s33, v124
    v_dot2_f32_bf16 v125, v134, v134, v125
    v_dot2_f32_bf16 v124, v135, s33, v124
    v_dot2_f32_bf16 v125, v135, v135, v125
    s_waitcnt vmcnt(4)
    s_barrier
    ds_read_b128 v[24:27], v14 offset:32768
    ds_read_b128 v[28:31], v14 offset:34816
    ds_read_b64_tr_b16 v[32:33], v16 offset:32768
    ds_read_b64_tr_b16 v[34:35], v16 offset:33792
    ds_read_b64_tr_b16 v[36:37], v17 offset:32768
    ds_read_b64_tr_b16 v[38:39], v17 offset:33792
    ds_read_b128 v[40:43], v15 offset:32768
    ds_read_b128 v[44:47], v15 offset:34816
    ds_read_b64_tr_b16 v[48:49], v16 offset:36864
    ds_read_b64_tr_b16 v[50:51], v16 offset:37888
    ds_read_b64_tr_b16 v[52:53], v17 offset:36864
    ds_read_b64_tr_b16 v[54:55], v17 offset:37888
    ds_read_b128 v[128:131], v22 offset:32768
    ds_read_b128 v[132:135], v22 offset:32784
    s_waitcnt lgkmcnt(8)
    v_mfma_f32_32x32x16_bf16 v[56:71], v[32:35], v[24:27], v[56:71]
    v_mfma_f32_32x32x16_bf16 v[72:87], v[36:39], v[24:27], v[72:87]
    v_mfma_f32_32x32x16_bf16 v[88:103], v[32:35], v[28:31], v[88:103]
    v_mfma_f32_32x32x16_bf16 v[104:119], v[36:39], v[28:31], v[104:119]
    v_dot2_f32_bf16 v120, v32, s33, v120
    v_dot2_f32_bf16 v120, v33, s33, v120
    v_dot2_f32_bf16 v120, v34, s33, v120
    v_dot2_f32_bf16 v120, v35, s33, v120
    v_dot2_f32_bf16 v121, v36, s33, v121
    v_dot2_f32_bf16 v121, v37, s33, v121
    v_dot2_f32_bf16 v121, v38, s33, v121
    v_dot2_f32_bf16 v121, v39, s33, v121
    s_waitcnt lgkmcnt(0)
    v_mfma_f32_32x32x16_bf16 v[56:71], v[48:51], v[40:43], v[56:71]
    v_mfma_f32_32x32x16_bf16 v[72:87], v[52:55], v[40:43], v[72:87]
    v_mfma_f32_32x32x16_bf16 v[88:103], v[48:51], v[44:47], v[88:103]
    v_mfma_f32_32x32x16_bf16 v[104:119], v[52:55], v[44:47], v[104:119]
    v_dot2_f32_bf16 v120, v48, s33, v120
    v_dot2_f32_bf16 v120, v49, s33, v120
    v_dot2_f32_bf16 v120, v50, s33, v120
    v_dot2_f32_bf16 v120, v51, s33, v120
    v_dot2_f32_bf16 v121, v52, s33, v121
    v_dot2_f32_bf16 v121, v53, s33, v121
    v_dot2_f32_bf16 v121, v54, s33, v121
    v_dot2_f32_bf16 v121, v55, s33, v121
    v_dot2_f32_bf16 v124, v128, s33, v124
    v_dot2_f32_bf16 v125, v128, v128, v125
    v_dot2_f32_bf16 v124, v129, s33, v124
    v_dot2_f32_bf16 v125, v129, v129, v125
    v_dot2_f32_bf16 v124, v130, s33, v124
    v_dot2_f32_bf16 v125, v130, v130, v125
    v_dot2_f32_bf16 v124, v131, s33, v124
    v_dot2_f32_bf16 v125, v131, v131, v125
    v_dot2_f32_bf16 v124, v132, s33, v124
    v_dot2_f32_bf16 v125, v132, v132, v125
    v_dot2_f32_bf16 v124, v133, s33, v124
    v_dot2_f32_bf16 v125, v133, v133, v125
    v_dot2_f32_bf16 v124, v134, s33, v124
    v_dot2_f32_bf16 v125, v134, v134, v125
    v_dot2_f32_bf16 v124, v135, s33, v124
    v_dot2_f32_bf16 v125, v135, v135, v125
    s_waitcnt vmcnt(0)
    s_barrier
    ds_read_b128 v[24:27], v14 offset:49152
    ds_read_b128 v[28:31], v14 offset:51200
    ds_read_b64_tr_b16 v[32:33], v16 offset:49152
    ds_read_b64_tr_b16 v[34:35], v16 offset:50176
    ds_read_b64_tr_b16 v[36:37], v17 offset:49152
    ds_read_b64_tr_b16 v[38:39], v17 offset:50176
    ds_read_b128 v[40:43], v15 offset:49152
    ds_read_b128 v[44:47], v15 offset:51200
    ds_read_b64_tr_b16 v[48:49], v16 offset:53248
    ds_read_b64_tr_b16 v[50:51], v16 offset:54272
    ds_read_b64_tr_b16 v[52:53], v17 offset:53248
    ds_read_b64_tr_b16 v[54:55], v17 offset:54272
    ds_read_b128 v[128:131], v22 offset:49152
    ds_read_b128 v[132:135], v22 offset:49168
    s_waitcnt lgkmcnt(8)
    v_mfma_f32_32x32x16_bf16 v[56:71], v[32:35], v[24:27], v[56:71]
    v_mfma_f32_32x32x16_bf16 v[72:87], v[36:39], v[24:27], v[72:87]
    v_mfma_f32_32x32x16_bf16 v[88:103], v[32:35], v[28:31], v[88:103]
    v_mfma_f32_32x32x16_bf16 v[104:119], v[36:39], v[28:31], v[104:119]
    v_dot2_f32_bf16 v120, v32, s33, v120
    v_dot2_f32_bf16 v120, v33, s33, v120
    v_dot2_f32_bf16 v120, v34, s33, v120
    v_dot2_f32_bf16 v120, v35, s33, v120
    v_dot2_f32_bf16 v121, v36, s33, v121
    v_dot2_f32_bf16 v121, v37, s33, v121
    v_dot2_f32_bf16 v121, v38, s33, v121
    v_dot2_f32_bf16 v121, v39, s33, v121
    s_waitcnt lgkmcnt(0)
    v_mfma_f32_32x32x16_bf16 v[56:71], v[48:51], v[40:43], v[56:71]
    v_mfma_f32_32x32x16_bf16 v[72:87], v[52:55], v[40:43], v[72:87]
    v_mfma_f32_32x32x16_bf16 v[88:103], v[48:51], v[44:47], v[88:103]
    v_mfma_f32_32x32x16_bf16 v[104:119], v[52:55], v[44:47], v[104:119]
    v_dot2_f32_bf16 v120, v48, s33, v120
    v_dot2_f32_bf16 v120, v49, s33, v120
    v_dot2_f32_bf16 v120, v50, s33, v120
    v_dot2_f32_bf16 v120, v51, s33, v120
    v_dot2_f32_bf16 v121, v52, s33, v121
    v_dot2_f32_bf16 v121, v53, s33, v121
    v_dot2_f32_bf16 v121, v54, s33, v121
    v_dot2_f32_bf16 v121, v55, s33, v121
    v_dot2_f32_bf16 v124, v128, s33, v124
    v_dot2_f32_bf16 v125, v128, v128, v125
    v_dot2_f32_bf16 v124, v129, s33, v124
    v_dot2_f32_bf16 v125, v129, v129, v125
    v_dot2_f32_bf16 v124, v130, s33, v124
    v_dot2_f32_bf16 v125, v130, v130, v125
    v_dot2_f32_bf16 v124, v131, s33, v124
    v_dot2_f32_bf16 v125, v131, v131, v125
    v_dot2_f32_bf16 v124, v132, s33, v124
    v_dot2_f32_bf16 v125, v132, v132, v125
    v_dot2_f32_bf16 v124, v133, s33, v124
    v_dot2_f32_bf16 v125, v133, v133, v125
    v_dot2_f32_bf16 v124, v134, s33, v124
    v_dot2_f32_bf16 v125, v134, v134, v125
    v_dot2_f32_bf16 v124, v135, s33, v124
    v_dot2_f32_bf16 v125, v135, v135, v125
    v_mov_b32 v24, v124
    v_mov_b32 v25, v125
    ds_swizzle_b32 v26, v24 offset:1055
    ds_swizzle_b32 v27, v25 offset:1055
    s_waitcnt lgkmcnt(0)
    v_add_f32 v24, v24, v26
    v_add_f32 v25, v25, v27
    v_mul_f32 v24, 0x3b000000, v24
    v_mul_f32 v25, 0x3b000000, v25
    v_fma_f32 v25, -v24, v24, v25
    v_cvt_pk_bf16_f32 v26, v24, v25
    v_lshlrev_b32 v24, 16, v26
    v_and_b32 v25, 0xffff0000, v26
    v_add_f32 v25, 0x3727c5ac, v25
    v_cvt_pk_bf16_f32 v26, v25, v25
    v_lshlrev_b32 v25, 16, v26
    v_sqrt_f32 v25, v25
    s_nop 0
    v_cvt_pk_bf16_f32 v26, v25, v25
    v_lshlrev_b32 v25, 16, v26
    v_rcp_f32 v25, v25
    v_lshlrev_b32 v26, 3, v20
    v_add_u32 v26, 65536, v26
    ds_write_b64 v26, v[24:25]
    v_xor_b32 v26, 32, v2
    v_lshlrev_b32 v26, 2, v26
    ds_bpermute_b32 v27, v26, v120
    s_waitcnt lgkmcnt(0)
    v_add_f32 v120, v120, v27
    v_mul_u32_u24 v27, 2, v4
    v_add_u32 v27, 0, v27
    v_lshl_add_u32 v27, v27, 5, v5
    v_lshlrev_b32 v27, 2, v27
    v_add_u32 v27, 66560, v27
    ds_write_b32 v27, v120
    ds_bpermute_b32 v27, v26, v121
    s_waitcnt lgkmcnt(0)
    v_add_f32 v121, v121, v27
    v_mul_u32_u24 v27, 2, v4
    v_add_u32 v27, 1, v27
    v_lshl_add_u32 v27, v27, 5, v5
    v_lshlrev_b32 v27, 2, v27
    v_add_u32 v27, 66560, v27
    ds_write_b32 v27, v121
    s_waitcnt lgkmcnt(0)
    s_barrier
    v_mul_u32_u24 v7, 64, v3
    v_add_u32 v7, v7, v5
    s_mul_i32 s22, s20, 128
    v_add_u32 v7, s22, v7
    s_mov_b32 s24, 2816
    v_mul_lo_u32 v7, v7, s24
    v_mul_u32_u24 v8, 64, v4
    v_lshl_add_u32 v8, v6, 2, v8
    s_mul_i32 s23, s21, 128
    v_add_u32 v8, s23, v8
    v_lshl_add_u32 v7, v8, 1, v7
    s_mov_b32 s27, 0xbfb8aa3b
    v_mul_u32_u24 v26, 64, v3
    v_add_u32 v26, 0, v26
    v_add_u32 v26, v26, v5
    v_lshlrev_b32 v26, 3, v26
    v_add_u32 v26, 65536, v26
    ds_read_b64 v[28:29], v26
    v_mul_u32_u24 v26, 2, v4
    v_add_u32 v26, 0, v26
    v_lshlrev_b32 v26, 5, v26
    v_lshl_add_u32 v26, v6, 2, v26
    v_lshlrev_b32 v26, 2, v26
    v_add_u32 v26, 66560, v26
    ds_read_b128 v[32:35], v26 offset:0
    s_waitcnt lgkmcnt(0)
    v_fma_f32 v56, -v28, v32, v56
    v_mul_f32 v56, v56, v29
    v_fma_f32 v57, -v28, v33, v57
    v_mul_f32 v57, v57, v29
    v_fma_f32 v58, -v28, v34, v58
    v_mul_f32 v58, v58, v29
    v_fma_f32 v59, -v28, v35, v59
    v_mul_f32 v59, v59, v29
    v_cvt_pk_bf16_f32 v144, v56, v57
    v_lshlrev_b32 v148, 16, v144
    v_and_b32 v149, 0xffff0000, v144
    v_cvt_pk_bf16_f32 v145, v58, v59
    v_lshlrev_b32 v150, 16, v145
    v_and_b32 v151, 0xffff0000, v145
    v_mul_f32 v152, s27, v148
    v_exp_f32 v152, v152
    v_mul_f32 v153, s27, v149
    v_exp_f32 v153, v153
    v_mul_f32 v154, s27, v150
    v_exp_f32 v154, v154
    v_mul_f32 v155, s27, v151
    v_exp_f32 v155, v155
    v_add_f32 v152, 1.0, v152
    v_rcp_f32 v152, v152
    v_add_f32 v153, 1.0, v153
    v_rcp_f32 v153, v153
    v_add_f32 v154, 1.0, v154
    v_rcp_f32 v154, v154
    v_add_f32 v155, 1.0, v155
    v_rcp_f32 v155, v155
    v_mul_f32 v148, v148, v152
    v_mul_f32 v149, v149, v153
    v_mul_f32 v150, v150, v154
    v_mul_f32 v151, v151, v155
    v_cvt_pk_bf16_f32 v156, v148, v149
    v_cvt_pk_bf16_f32 v157, v150, v151
    s_mov_b32 s26, 22020096
    buffer_store_dwordx2 v[156:157], v7, s[12:15], s26 offen
    v_mul_u32_u24 v26, 2, v4
    v_add_u32 v26, 0, v26
    v_lshlrev_b32 v26, 5, v26
    v_lshl_add_u32 v26, v6, 2, v26
    v_lshlrev_b32 v26, 2, v26
    v_add_u32 v26, 66560, v26
    ds_read_b128 v[32:35], v26 offset:32
    s_waitcnt lgkmcnt(0)
    v_fma_f32 v60, -v28, v32, v60
    v_mul_f32 v60, v60, v29
    v_fma_f32 v61, -v28, v33, v61
    v_mul_f32 v61, v61, v29
    v_fma_f32 v62, -v28, v34, v62
    v_mul_f32 v62, v62, v29
    v_fma_f32 v63, -v28, v35, v63
    v_mul_f32 v63, v63, v29
    v_cvt_pk_bf16_f32 v144, v60, v61
    v_lshlrev_b32 v148, 16, v144
    v_and_b32 v149, 0xffff0000, v144
    v_cvt_pk_bf16_f32 v145, v62, v63
    v_lshlrev_b32 v150, 16, v145
    v_and_b32 v151, 0xffff0000, v145
    v_mul_f32 v152, s27, v148
    v_exp_f32 v152, v152
    v_mul_f32 v153, s27, v149
    v_exp_f32 v153, v153
    v_mul_f32 v154, s27, v150
    v_exp_f32 v154, v154
    v_mul_f32 v155, s27, v151
    v_exp_f32 v155, v155
    v_add_f32 v152, 1.0, v152
    v_rcp_f32 v152, v152
    v_add_f32 v153, 1.0, v153
    v_rcp_f32 v153, v153
    v_add_f32 v154, 1.0, v154
    v_rcp_f32 v154, v154
    v_add_f32 v155, 1.0, v155
    v_rcp_f32 v155, v155
    v_mul_f32 v148, v148, v152
    v_mul_f32 v149, v149, v153
    v_mul_f32 v150, v150, v154
    v_mul_f32 v151, v151, v155
    v_cvt_pk_bf16_f32 v158, v148, v149
    v_cvt_pk_bf16_f32 v159, v150, v151
    s_mov_b32 s26, 22020112
    buffer_store_dwordx2 v[158:159], v7, s[12:15], s26 offen
    v_mul_u32_u24 v26, 2, v4
    v_add_u32 v26, 0, v26
    v_lshlrev_b32 v26, 5, v26
    v_lshl_add_u32 v26, v6, 2, v26
    v_lshlrev_b32 v26, 2, v26
    v_add_u32 v26, 66560, v26
    ds_read_b128 v[32:35], v26 offset:64
    s_waitcnt lgkmcnt(0)
    v_fma_f32 v64, -v28, v32, v64
    v_mul_f32 v64, v64, v29
    v_fma_f32 v65, -v28, v33, v65
    v_mul_f32 v65, v65, v29
    v_fma_f32 v66, -v28, v34, v66
    v_mul_f32 v66, v66, v29
    v_fma_f32 v67, -v28, v35, v67
    v_mul_f32 v67, v67, v29
    v_cvt_pk_bf16_f32 v144, v64, v65
    v_lshlrev_b32 v148, 16, v144
    v_and_b32 v149, 0xffff0000, v144
    v_cvt_pk_bf16_f32 v145, v66, v67
    v_lshlrev_b32 v150, 16, v145
    v_and_b32 v151, 0xffff0000, v145
    v_mul_f32 v152, s27, v148
    v_exp_f32 v152, v152
    v_mul_f32 v153, s27, v149
    v_exp_f32 v153, v153
    v_mul_f32 v154, s27, v150
    v_exp_f32 v154, v154
    v_mul_f32 v155, s27, v151
    v_exp_f32 v155, v155
    v_add_f32 v152, 1.0, v152
    v_rcp_f32 v152, v152
    v_add_f32 v153, 1.0, v153
    v_rcp_f32 v153, v153
    v_add_f32 v154, 1.0, v154
    v_rcp_f32 v154, v154
    v_add_f32 v155, 1.0, v155
    v_rcp_f32 v155, v155
    v_mul_f32 v148, v148, v152
    v_mul_f32 v149, v149, v153
    v_mul_f32 v150, v150, v154
    v_mul_f32 v151, v151, v155
    v_cvt_pk_bf16_f32 v156, v148, v149
    v_cvt_pk_bf16_f32 v157, v150, v151
    s_mov_b32 s26, 22020128
    buffer_store_dwordx2 v[156:157], v7, s[12:15], s26 offen
    v_mul_u32_u24 v26, 2, v4
    v_add_u32 v26, 0, v26
    v_lshlrev_b32 v26, 5, v26
    v_lshl_add_u32 v26, v6, 2, v26
    v_lshlrev_b32 v26, 2, v26
    v_add_u32 v26, 66560, v26
    ds_read_b128 v[32:35], v26 offset:96
    s_waitcnt lgkmcnt(0)
    v_fma_f32 v68, -v28, v32, v68
    v_mul_f32 v68, v68, v29
    v_fma_f32 v69, -v28, v33, v69
    v_mul_f32 v69, v69, v29
    v_fma_f32 v70, -v28, v34, v70
    v_mul_f32 v70, v70, v29
    v_fma_f32 v71, -v28, v35, v71
    v_mul_f32 v71, v71, v29
    v_cvt_pk_bf16_f32 v144, v68, v69
    v_lshlrev_b32 v148, 16, v144
    v_and_b32 v149, 0xffff0000, v144
    v_cvt_pk_bf16_f32 v145, v70, v71
    v_lshlrev_b32 v150, 16, v145
    v_and_b32 v151, 0xffff0000, v145
    v_mul_f32 v152, s27, v148
    v_exp_f32 v152, v152
    v_mul_f32 v153, s27, v149
    v_exp_f32 v153, v153
    v_mul_f32 v154, s27, v150
    v_exp_f32 v154, v154
    v_mul_f32 v155, s27, v151
    v_exp_f32 v155, v155
    v_add_f32 v152, 1.0, v152
    v_rcp_f32 v152, v152
    v_add_f32 v153, 1.0, v153
    v_rcp_f32 v153, v153
    v_add_f32 v154, 1.0, v154
    v_rcp_f32 v154, v154
    v_add_f32 v155, 1.0, v155
    v_rcp_f32 v155, v155
    v_mul_f32 v148, v148, v152
    v_mul_f32 v149, v149, v153
    v_mul_f32 v150, v150, v154
    v_mul_f32 v151, v151, v155
    v_cvt_pk_bf16_f32 v158, v148, v149
    v_cvt_pk_bf16_f32 v159, v150, v151
    s_mov_b32 s26, 22020144
    buffer_store_dwordx2 v[158:159], v7, s[12:15], s26 offen
    v_mul_u32_u24 v26, 64, v3
    v_add_u32 v26, 0, v26
    v_add_u32 v26, v26, v5
    v_lshlrev_b32 v26, 3, v26
    v_add_u32 v26, 65536, v26
    ds_read_b64 v[28:29], v26
    v_mul_u32_u24 v26, 2, v4
    v_add_u32 v26, 1, v26
    v_lshlrev_b32 v26, 5, v26
    v_lshl_add_u32 v26, v6, 2, v26
    v_lshlrev_b32 v26, 2, v26
    v_add_u32 v26, 66560, v26
    ds_read_b128 v[32:35], v26 offset:0
    s_waitcnt lgkmcnt(0)
    v_fma_f32 v72, -v28, v32, v72
    v_mul_f32 v72, v72, v29
    v_fma_f32 v73, -v28, v33, v73
    v_mul_f32 v73, v73, v29
    v_fma_f32 v74, -v28, v34, v74
    v_mul_f32 v74, v74, v29
    v_fma_f32 v75, -v28, v35, v75
    v_mul_f32 v75, v75, v29
    v_cvt_pk_bf16_f32 v144, v72, v73
    v_lshlrev_b32 v148, 16, v144
    v_and_b32 v149, 0xffff0000, v144
    v_cvt_pk_bf16_f32 v145, v74, v75
    v_lshlrev_b32 v150, 16, v145
    v_and_b32 v151, 0xffff0000, v145
    v_mul_f32 v152, s27, v148
    v_exp_f32 v152, v152
    v_mul_f32 v153, s27, v149
    v_exp_f32 v153, v153
    v_mul_f32 v154, s27, v150
    v_exp_f32 v154, v154
    v_mul_f32 v155, s27, v151
    v_exp_f32 v155, v155
    v_add_f32 v152, 1.0, v152
    v_rcp_f32 v152, v152
    v_add_f32 v153, 1.0, v153
    v_rcp_f32 v153, v153
    v_add_f32 v154, 1.0, v154
    v_rcp_f32 v154, v154
    v_add_f32 v155, 1.0, v155
    v_rcp_f32 v155, v155
    v_mul_f32 v148, v148, v152
    v_mul_f32 v149, v149, v153
    v_mul_f32 v150, v150, v154
    v_mul_f32 v151, v151, v155
    v_cvt_pk_bf16_f32 v156, v148, v149
    v_cvt_pk_bf16_f32 v157, v150, v151
    s_mov_b32 s26, 22020160
    buffer_store_dwordx2 v[156:157], v7, s[12:15], s26 offen
    v_mul_u32_u24 v26, 2, v4
    v_add_u32 v26, 1, v26
    v_lshlrev_b32 v26, 5, v26
    v_lshl_add_u32 v26, v6, 2, v26
    v_lshlrev_b32 v26, 2, v26
    v_add_u32 v26, 66560, v26
    ds_read_b128 v[32:35], v26 offset:32
    s_waitcnt lgkmcnt(0)
    v_fma_f32 v76, -v28, v32, v76
    v_mul_f32 v76, v76, v29
    v_fma_f32 v77, -v28, v33, v77
    v_mul_f32 v77, v77, v29
    v_fma_f32 v78, -v28, v34, v78
    v_mul_f32 v78, v78, v29
    v_fma_f32 v79, -v28, v35, v79
    v_mul_f32 v79, v79, v29
    v_cvt_pk_bf16_f32 v144, v76, v77
    v_lshlrev_b32 v148, 16, v144
    v_and_b32 v149, 0xffff0000, v144
    v_cvt_pk_bf16_f32 v145, v78, v79
    v_lshlrev_b32 v150, 16, v145
    v_and_b32 v151, 0xffff0000, v145
    v_mul_f32 v152, s27, v148
    v_exp_f32 v152, v152
    v_mul_f32 v153, s27, v149
    v_exp_f32 v153, v153
    v_mul_f32 v154, s27, v150
    v_exp_f32 v154, v154
    v_mul_f32 v155, s27, v151
    v_exp_f32 v155, v155
    v_add_f32 v152, 1.0, v152
    v_rcp_f32 v152, v152
    v_add_f32 v153, 1.0, v153
    v_rcp_f32 v153, v153
    v_add_f32 v154, 1.0, v154
    v_rcp_f32 v154, v154
    v_add_f32 v155, 1.0, v155
    v_rcp_f32 v155, v155
    v_mul_f32 v148, v148, v152
    v_mul_f32 v149, v149, v153
    v_mul_f32 v150, v150, v154
    v_mul_f32 v151, v151, v155
    v_cvt_pk_bf16_f32 v158, v148, v149
    v_cvt_pk_bf16_f32 v159, v150, v151
    s_mov_b32 s26, 22020176
    buffer_store_dwordx2 v[158:159], v7, s[12:15], s26 offen
    v_mul_u32_u24 v26, 2, v4
    v_add_u32 v26, 1, v26
    v_lshlrev_b32 v26, 5, v26
    v_lshl_add_u32 v26, v6, 2, v26
    v_lshlrev_b32 v26, 2, v26
    v_add_u32 v26, 66560, v26
    ds_read_b128 v[32:35], v26 offset:64
    s_waitcnt lgkmcnt(0)
    v_fma_f32 v80, -v28, v32, v80
    v_mul_f32 v80, v80, v29
    v_fma_f32 v81, -v28, v33, v81
    v_mul_f32 v81, v81, v29
    v_fma_f32 v82, -v28, v34, v82
    v_mul_f32 v82, v82, v29
    v_fma_f32 v83, -v28, v35, v83
    v_mul_f32 v83, v83, v29
    v_cvt_pk_bf16_f32 v144, v80, v81
    v_lshlrev_b32 v148, 16, v144
    v_and_b32 v149, 0xffff0000, v144
    v_cvt_pk_bf16_f32 v145, v82, v83
    v_lshlrev_b32 v150, 16, v145
    v_and_b32 v151, 0xffff0000, v145
    v_mul_f32 v152, s27, v148
    v_exp_f32 v152, v152
    v_mul_f32 v153, s27, v149
    v_exp_f32 v153, v153
    v_mul_f32 v154, s27, v150
    v_exp_f32 v154, v154
    v_mul_f32 v155, s27, v151
    v_exp_f32 v155, v155
    v_add_f32 v152, 1.0, v152
    v_rcp_f32 v152, v152
    v_add_f32 v153, 1.0, v153
    v_rcp_f32 v153, v153
    v_add_f32 v154, 1.0, v154
    v_rcp_f32 v154, v154
    v_add_f32 v155, 1.0, v155
    v_rcp_f32 v155, v155
    v_mul_f32 v148, v148, v152
    v_mul_f32 v149, v149, v153
    v_mul_f32 v150, v150, v154
    v_mul_f32 v151, v151, v155
    v_cvt_pk_bf16_f32 v156, v148, v149
    v_cvt_pk_bf16_f32 v157, v150, v151
    s_mov_b32 s26, 22020192
    buffer_store_dwordx2 v[156:157], v7, s[12:15], s26 offen
    v_mul_u32_u24 v26, 2, v4
    v_add_u32 v26, 1, v26
    v_lshlrev_b32 v26, 5, v26
    v_lshl_add_u32 v26, v6, 2, v26
    v_lshlrev_b32 v26, 2, v26
    v_add_u32 v26, 66560, v26
    ds_read_b128 v[32:35], v26 offset:96
    s_waitcnt lgkmcnt(0)
    v_fma_f32 v84, -v28, v32, v84
    v_mul_f32 v84, v84, v29
    v_fma_f32 v85, -v28, v33, v85
    v_mul_f32 v85, v85, v29
    v_fma_f32 v86, -v28, v34, v86
    v_mul_f32 v86, v86, v29
    v_fma_f32 v87, -v28, v35, v87
    v_mul_f32 v87, v87, v29
    v_cvt_pk_bf16_f32 v144, v84, v85
    v_lshlrev_b32 v148, 16, v144
    v_and_b32 v149, 0xffff0000, v144
    v_cvt_pk_bf16_f32 v145, v86, v87
    v_lshlrev_b32 v150, 16, v145
    v_and_b32 v151, 0xffff0000, v145
    v_mul_f32 v152, s27, v148
    v_exp_f32 v152, v152
    v_mul_f32 v153, s27, v149
    v_exp_f32 v153, v153
    v_mul_f32 v154, s27, v150
    v_exp_f32 v154, v154
    v_mul_f32 v155, s27, v151
    v_exp_f32 v155, v155
    v_add_f32 v152, 1.0, v152
    v_rcp_f32 v152, v152
    v_add_f32 v153, 1.0, v153
    v_rcp_f32 v153, v153
    v_add_f32 v154, 1.0, v154
    v_rcp_f32 v154, v154
    v_add_f32 v155, 1.0, v155
    v_rcp_f32 v155, v155
    v_mul_f32 v148, v148, v152
    v_mul_f32 v149, v149, v153
    v_mul_f32 v150, v150, v154
    v_mul_f32 v151, v151, v155
    v_cvt_pk_bf16_f32 v158, v148, v149
    v_cvt_pk_bf16_f32 v159, v150, v151
    s_mov_b32 s26, 22020208
    buffer_store_dwordx2 v[158:159], v7, s[12:15], s26 offen
    v_mul_u32_u24 v26, 64, v3
    v_add_u32 v26, 32, v26
    v_add_u32 v26, v26, v5
    v_lshlrev_b32 v26, 3, v26
    v_add_u32 v26, 65536, v26
    ds_read_b64 v[28:29], v26
    v_mul_u32_u24 v26, 2, v4
    v_add_u32 v26, 0, v26
    v_lshlrev_b32 v26, 5, v26
    v_lshl_add_u32 v26, v6, 2, v26
    v_lshlrev_b32 v26, 2, v26
    v_add_u32 v26, 66560, v26
    ds_read_b128 v[32:35], v26 offset:0
    s_waitcnt lgkmcnt(0)
    v_fma_f32 v88, -v28, v32, v88
    v_mul_f32 v88, v88, v29
    v_fma_f32 v89, -v28, v33, v89
    v_mul_f32 v89, v89, v29
    v_fma_f32 v90, -v28, v34, v90
    v_mul_f32 v90, v90, v29
    v_fma_f32 v91, -v28, v35, v91
    v_mul_f32 v91, v91, v29
    v_cvt_pk_bf16_f32 v144, v88, v89
    v_lshlrev_b32 v148, 16, v144
    v_and_b32 v149, 0xffff0000, v144
    v_cvt_pk_bf16_f32 v145, v90, v91
    v_lshlrev_b32 v150, 16, v145
    v_and_b32 v151, 0xffff0000, v145
    v_mul_f32 v152, s27, v148
    v_exp_f32 v152, v152
    v_mul_f32 v153, s27, v149
    v_exp_f32 v153, v153
    v_mul_f32 v154, s27, v150
    v_exp_f32 v154, v154
    v_mul_f32 v155, s27, v151
    v_exp_f32 v155, v155
    v_add_f32 v152, 1.0, v152
    v_rcp_f32 v152, v152
    v_add_f32 v153, 1.0, v153
    v_rcp_f32 v153, v153
    v_add_f32 v154, 1.0, v154
    v_rcp_f32 v154, v154
    v_add_f32 v155, 1.0, v155
    v_rcp_f32 v155, v155
    v_mul_f32 v148, v148, v152
    v_mul_f32 v149, v149, v153
    v_mul_f32 v150, v150, v154
    v_mul_f32 v151, v151, v155
    v_cvt_pk_bf16_f32 v156, v148, v149
    v_cvt_pk_bf16_f32 v157, v150, v151
    s_mov_b32 s26, 22110208
    buffer_store_dwordx2 v[156:157], v7, s[12:15], s26 offen
    v_mul_u32_u24 v26, 2, v4
    v_add_u32 v26, 0, v26
    v_lshlrev_b32 v26, 5, v26
    v_lshl_add_u32 v26, v6, 2, v26
    v_lshlrev_b32 v26, 2, v26
    v_add_u32 v26, 66560, v26
    ds_read_b128 v[32:35], v26 offset:32
    s_waitcnt lgkmcnt(0)
    v_fma_f32 v92, -v28, v32, v92
    v_mul_f32 v92, v92, v29
    v_fma_f32 v93, -v28, v33, v93
    v_mul_f32 v93, v93, v29
    v_fma_f32 v94, -v28, v34, v94
    v_mul_f32 v94, v94, v29
    v_fma_f32 v95, -v28, v35, v95
    v_mul_f32 v95, v95, v29
    v_cvt_pk_bf16_f32 v144, v92, v93
    v_lshlrev_b32 v148, 16, v144
    v_and_b32 v149, 0xffff0000, v144
    v_cvt_pk_bf16_f32 v145, v94, v95
    v_lshlrev_b32 v150, 16, v145
    v_and_b32 v151, 0xffff0000, v145
    v_mul_f32 v152, s27, v148
    v_exp_f32 v152, v152
    v_mul_f32 v153, s27, v149
    v_exp_f32 v153, v153
    v_mul_f32 v154, s27, v150
    v_exp_f32 v154, v154
    v_mul_f32 v155, s27, v151
    v_exp_f32 v155, v155
    v_add_f32 v152, 1.0, v152
    v_rcp_f32 v152, v152
    v_add_f32 v153, 1.0, v153
    v_rcp_f32 v153, v153
    v_add_f32 v154, 1.0, v154
    v_rcp_f32 v154, v154
    v_add_f32 v155, 1.0, v155
    v_rcp_f32 v155, v155
    v_mul_f32 v148, v148, v152
    v_mul_f32 v149, v149, v153
    v_mul_f32 v150, v150, v154
    v_mul_f32 v151, v151, v155
    v_cvt_pk_bf16_f32 v158, v148, v149
    v_cvt_pk_bf16_f32 v159, v150, v151
    s_mov_b32 s26, 22110224
    buffer_store_dwordx2 v[158:159], v7, s[12:15], s26 offen
    v_mul_u32_u24 v26, 2, v4
    v_add_u32 v26, 0, v26
    v_lshlrev_b32 v26, 5, v26
    v_lshl_add_u32 v26, v6, 2, v26
    v_lshlrev_b32 v26, 2, v26
    v_add_u32 v26, 66560, v26
    ds_read_b128 v[32:35], v26 offset:64
    s_waitcnt lgkmcnt(0)
    v_fma_f32 v96, -v28, v32, v96
    v_mul_f32 v96, v96, v29
    v_fma_f32 v97, -v28, v33, v97
    v_mul_f32 v97, v97, v29
    v_fma_f32 v98, -v28, v34, v98
    v_mul_f32 v98, v98, v29
    v_fma_f32 v99, -v28, v35, v99
    v_mul_f32 v99, v99, v29
    v_cvt_pk_bf16_f32 v144, v96, v97
    v_lshlrev_b32 v148, 16, v144
    v_and_b32 v149, 0xffff0000, v144
    v_cvt_pk_bf16_f32 v145, v98, v99
    v_lshlrev_b32 v150, 16, v145
    v_and_b32 v151, 0xffff0000, v145
    v_mul_f32 v152, s27, v148
    v_exp_f32 v152, v152
    v_mul_f32 v153, s27, v149
    v_exp_f32 v153, v153
    v_mul_f32 v154, s27, v150
    v_exp_f32 v154, v154
    v_mul_f32 v155, s27, v151
    v_exp_f32 v155, v155
    v_add_f32 v152, 1.0, v152
    v_rcp_f32 v152, v152
    v_add_f32 v153, 1.0, v153
    v_rcp_f32 v153, v153
    v_add_f32 v154, 1.0, v154
    v_rcp_f32 v154, v154
    v_add_f32 v155, 1.0, v155
    v_rcp_f32 v155, v155
    v_mul_f32 v148, v148, v152
    v_mul_f32 v149, v149, v153
    v_mul_f32 v150, v150, v154
    v_mul_f32 v151, v151, v155
    v_cvt_pk_bf16_f32 v156, v148, v149
    v_cvt_pk_bf16_f32 v157, v150, v151
    s_mov_b32 s26, 22110240
    buffer_store_dwordx2 v[156:157], v7, s[12:15], s26 offen
    v_mul_u32_u24 v26, 2, v4
    v_add_u32 v26, 0, v26
    v_lshlrev_b32 v26, 5, v26
    v_lshl_add_u32 v26, v6, 2, v26
    v_lshlrev_b32 v26, 2, v26
    v_add_u32 v26, 66560, v26
    ds_read_b128 v[32:35], v26 offset:96
    s_waitcnt lgkmcnt(0)
    v_fma_f32 v100, -v28, v32, v100
    v_mul_f32 v100, v100, v29
    v_fma_f32 v101, -v28, v33, v101
    v_mul_f32 v101, v101, v29
    v_fma_f32 v102, -v28, v34, v102
    v_mul_f32 v102, v102, v29
    v_fma_f32 v103, -v28, v35, v103
    v_mul_f32 v103, v103, v29
    v_cvt_pk_bf16_f32 v144, v100, v101
    v_lshlrev_b32 v148, 16, v144
    v_and_b32 v149, 0xffff0000, v144
    v_cvt_pk_bf16_f32 v145, v102, v103
    v_lshlrev_b32 v150, 16, v145
    v_and_b32 v151, 0xffff0000, v145
    v_mul_f32 v152, s27, v148
    v_exp_f32 v152, v152
    v_mul_f32 v153, s27, v149
    v_exp_f32 v153, v153
    v_mul_f32 v154, s27, v150
    v_exp_f32 v154, v154
    v_mul_f32 v155, s27, v151
    v_exp_f32 v155, v155
    v_add_f32 v152, 1.0, v152
    v_rcp_f32 v152, v152
    v_add_f32 v153, 1.0, v153
    v_rcp_f32 v153, v153
    v_add_f32 v154, 1.0, v154
    v_rcp_f32 v154, v154
    v_add_f32 v155, 1.0, v155
    v_rcp_f32 v155, v155
    v_mul_f32 v148, v148, v152
    v_mul_f32 v149, v149, v153
    v_mul_f32 v150, v150, v154
    v_mul_f32 v151, v151, v155
    v_cvt_pk_bf16_f32 v158, v148, v149
    v_cvt_pk_bf16_f32 v159, v150, v151
    s_mov_b32 s26, 22110256
    buffer_store_dwordx2 v[158:159], v7, s[12:15], s26 offen
    v_mul_u32_u24 v26, 64, v3
    v_add_u32 v26, 32, v26
    v_add_u32 v26, v26, v5
    v_lshlrev_b32 v26, 3, v26
    v_add_u32 v26, 65536, v26
    ds_read_b64 v[28:29], v26
    v_mul_u32_u24 v26, 2, v4
    v_add_u32 v26, 1, v26
    v_lshlrev_b32 v26, 5, v26
    v_lshl_add_u32 v26, v6, 2, v26
    v_lshlrev_b32 v26, 2, v26
    v_add_u32 v26, 66560, v26
    ds_read_b128 v[32:35], v26 offset:0
    s_waitcnt lgkmcnt(0)
    v_fma_f32 v104, -v28, v32, v104
    v_mul_f32 v104, v104, v29
    v_fma_f32 v105, -v28, v33, v105
    v_mul_f32 v105, v105, v29
    v_fma_f32 v106, -v28, v34, v106
    v_mul_f32 v106, v106, v29
    v_fma_f32 v107, -v28, v35, v107
    v_mul_f32 v107, v107, v29
    v_cvt_pk_bf16_f32 v144, v104, v105
    v_lshlrev_b32 v148, 16, v144
    v_and_b32 v149, 0xffff0000, v144
    v_cvt_pk_bf16_f32 v145, v106, v107
    v_lshlrev_b32 v150, 16, v145
    v_and_b32 v151, 0xffff0000, v145
    v_mul_f32 v152, s27, v148
    v_exp_f32 v152, v152
    v_mul_f32 v153, s27, v149
    v_exp_f32 v153, v153
    v_mul_f32 v154, s27, v150
    v_exp_f32 v154, v154
    v_mul_f32 v155, s27, v151
    v_exp_f32 v155, v155
    v_add_f32 v152, 1.0, v152
    v_rcp_f32 v152, v152
    v_add_f32 v153, 1.0, v153
    v_rcp_f32 v153, v153
    v_add_f32 v154, 1.0, v154
    v_rcp_f32 v154, v154
    v_add_f32 v155, 1.0, v155
    v_rcp_f32 v155, v155
    v_mul_f32 v148, v148, v152
    v_mul_f32 v149, v149, v153
    v_mul_f32 v150, v150, v154
    v_mul_f32 v151, v151, v155
    v_cvt_pk_bf16_f32 v156, v148, v149
    v_cvt_pk_bf16_f32 v157, v150, v151
    s_mov_b32 s26, 22110272
    buffer_store_dwordx2 v[156:157], v7, s[12:15], s26 offen
    v_mul_u32_u24 v26, 2, v4
    v_add_u32 v26, 1, v26
    v_lshlrev_b32 v26, 5, v26
    v_lshl_add_u32 v26, v6, 2, v26
    v_lshlrev_b32 v26, 2, v26
    v_add_u32 v26, 66560, v26
    ds_read_b128 v[32:35], v26 offset:32
    s_waitcnt lgkmcnt(0)
    v_fma_f32 v108, -v28, v32, v108
    v_mul_f32 v108, v108, v29
    v_fma_f32 v109, -v28, v33, v109
    v_mul_f32 v109, v109, v29
    v_fma_f32 v110, -v28, v34, v110
    v_mul_f32 v110, v110, v29
    v_fma_f32 v111, -v28, v35, v111
    v_mul_f32 v111, v111, v29
    v_cvt_pk_bf16_f32 v144, v108, v109
    v_lshlrev_b32 v148, 16, v144
    v_and_b32 v149, 0xffff0000, v144
    v_cvt_pk_bf16_f32 v145, v110, v111
    v_lshlrev_b32 v150, 16, v145
    v_and_b32 v151, 0xffff0000, v145
    v_mul_f32 v152, s27, v148
    v_exp_f32 v152, v152
    v_mul_f32 v153, s27, v149
    v_exp_f32 v153, v153
    v_mul_f32 v154, s27, v150
    v_exp_f32 v154, v154
    v_mul_f32 v155, s27, v151
    v_exp_f32 v155, v155
    v_add_f32 v152, 1.0, v152
    v_rcp_f32 v152, v152
    v_add_f32 v153, 1.0, v153
    v_rcp_f32 v153, v153
    v_add_f32 v154, 1.0, v154
    v_rcp_f32 v154, v154
    v_add_f32 v155, 1.0, v155
    v_rcp_f32 v155, v155
    v_mul_f32 v148, v148, v152
    v_mul_f32 v149, v149, v153
    v_mul_f32 v150, v150, v154
    v_mul_f32 v151, v151, v155
    v_cvt_pk_bf16_f32 v158, v148, v149
    v_cvt_pk_bf16_f32 v159, v150, v151
    s_mov_b32 s26, 22110288
    buffer_store_dwordx2 v[158:159], v7, s[12:15], s26 offen
    v_mul_u32_u24 v26, 2, v4
    v_add_u32 v26, 1, v26
    v_lshlrev_b32 v26, 5, v26
    v_lshl_add_u32 v26, v6, 2, v26
    v_lshlrev_b32 v26, 2, v26
    v_add_u32 v26, 66560, v26
    ds_read_b128 v[32:35], v26 offset:64
    s_waitcnt lgkmcnt(0)
    v_fma_f32 v112, -v28, v32, v112
    v_mul_f32 v112, v112, v29
    v_fma_f32 v113, -v28, v33, v113
    v_mul_f32 v113, v113, v29
    v_fma_f32 v114, -v28, v34, v114
    v_mul_f32 v114, v114, v29
    v_fma_f32 v115, -v28, v35, v115
    v_mul_f32 v115, v115, v29
    v_cvt_pk_bf16_f32 v144, v112, v113
    v_lshlrev_b32 v148, 16, v144
    v_and_b32 v149, 0xffff0000, v144
    v_cvt_pk_bf16_f32 v145, v114, v115
    v_lshlrev_b32 v150, 16, v145
    v_and_b32 v151, 0xffff0000, v145
    v_mul_f32 v152, s27, v148
    v_exp_f32 v152, v152
    v_mul_f32 v153, s27, v149
    v_exp_f32 v153, v153
    v_mul_f32 v154, s27, v150
    v_exp_f32 v154, v154
    v_mul_f32 v155, s27, v151
    v_exp_f32 v155, v155
    v_add_f32 v152, 1.0, v152
    v_rcp_f32 v152, v152
    v_add_f32 v153, 1.0, v153
    v_rcp_f32 v153, v153
    v_add_f32 v154, 1.0, v154
    v_rcp_f32 v154, v154
    v_add_f32 v155, 1.0, v155
    v_rcp_f32 v155, v155
    v_mul_f32 v148, v148, v152
    v_mul_f32 v149, v149, v153
    v_mul_f32 v150, v150, v154
    v_mul_f32 v151, v151, v155
    v_cvt_pk_bf16_f32 v156, v148, v149
    v_cvt_pk_bf16_f32 v157, v150, v151
    s_mov_b32 s26, 22110304
    buffer_store_dwordx2 v[156:157], v7, s[12:15], s26 offen
    v_mul_u32_u24 v26, 2, v4
    v_add_u32 v26, 1, v26
    v_lshlrev_b32 v26, 5, v26
    v_lshl_add_u32 v26, v6, 2, v26
    v_lshlrev_b32 v26, 2, v26
    v_add_u32 v26, 66560, v26
    ds_read_b128 v[32:35], v26 offset:96
    s_waitcnt lgkmcnt(0)
    v_fma_f32 v116, -v28, v32, v116
    v_mul_f32 v116, v116, v29
    v_fma_f32 v117, -v28, v33, v117
    v_mul_f32 v117, v117, v29
    v_fma_f32 v118, -v28, v34, v118
    v_mul_f32 v118, v118, v29
    v_fma_f32 v119, -v28, v35, v119
    v_mul_f32 v119, v119, v29
    v_cvt_pk_bf16_f32 v144, v116, v117
    v_lshlrev_b32 v148, 16, v144
    v_and_b32 v149, 0xffff0000, v144
    v_cvt_pk_bf16_f32 v145, v118, v119
    v_lshlrev_b32 v150, 16, v145
    v_and_b32 v151, 0xffff0000, v145
    v_mul_f32 v152, s27, v148
    v_exp_f32 v152, v152
    v_mul_f32 v153, s27, v149
    v_exp_f32 v153, v153
    v_mul_f32 v154, s27, v150
    v_exp_f32 v154, v154
    v_mul_f32 v155, s27, v151
    v_exp_f32 v155, v155
    v_add_f32 v152, 1.0, v152
    v_rcp_f32 v152, v152
    v_add_f32 v153, 1.0, v153
    v_rcp_f32 v153, v153
    v_add_f32 v154, 1.0, v154
    v_rcp_f32 v154, v154
    v_add_f32 v155, 1.0, v155
    v_rcp_f32 v155, v155
    v_mul_f32 v148, v148, v152
    v_mul_f32 v149, v149, v153
    v_mul_f32 v150, v150, v154
    v_mul_f32 v151, v151, v155
    v_cvt_pk_bf16_f32 v158, v148, v149
    v_cvt_pk_bf16_f32 v159, v150, v151
    s_mov_b32 s26, 22110320
    buffer_store_dwordx2 v[158:159], v7, s[12:15], s26 offen
Lend_g1:
    s_endpgm
Lrole_l1_1:
    s_sub_u32 s2, s2, 176
    s_cmp_ge_u32 s2, 416
    s_cbranch_scc1 Lend_k1
    s_load_dwordx2 s[4:5], s[0:1], 0
    s_load_dwordx2 s[6:7], s[0:1], 64
    s_load_dwordx4 s[28:31], s[0:1], 8
    s_load_dwordx4 s[32:35], s[0:1], 32
    s_waitcnt lgkmcnt(0)
    s_mov_b32 s8, s4
    s_and_b32 s9, s5, 0xffff
    s_mov_b32 s10, 2097152
    s_mov_b32 s11, 0x00020000
    s_mov_b32 s12, s6
    s_and_b32 s13, s7, 0xffff
    s_mov_b32 s14, 268435456
    s_mov_b32 s15, 0x00020000
    s_cmp_ge_u32 s2, 256
    s_cbranch_scc1 Ltrans_k1
    s_mov_b32 s16, 0x3f3504f3
    v_and_b32 v1, 63, v0
    v_lshrrev_b32 v2, 6, v0
    s_lshl_b32 s17, s2, 13
    v_lshlrev_b32 v3, 11, v2
    v_lshl_add_u32 v3, v1, 1, v3
    v_add_u32 v3, s17, v3
    v_xor_b32 v4, 32, v1
    v_lshlrev_b32 v4, 2, v4
    v_lshlrev_b32 v5, 12, v2
    buffer_load_ushort v8, v3, s[8:11], 0 offen offset:0
    buffer_load_ushort v9, v3, s[8:11], 0 offen offset:128
    buffer_load_ushort v10, v3, s[8:11], 0 offen offset:256
    buffer_load_ushort v11, v3, s[8:11], 0 offen offset:384
    buffer_load_ushort v12, v3, s[8:11], 0 offen offset:512
    buffer_load_ushort v13, v3, s[8:11], 0 offen offset:640
    buffer_load_ushort v14, v3, s[8:11], 0 offen offset:768
    buffer_load_ushort v15, v3, s[8:11], 0 offen offset:896
    buffer_load_ushort v16, v3, s[8:11], 0 offen offset:1024
    buffer_load_ushort v17, v3, s[8:11], 0 offen offset:1152
    buffer_load_ushort v18, v3, s[8:11], 0 offen offset:1280
    buffer_load_ushort v19, v3, s[8:11], 0 offen offset:1408
    buffer_load_ushort v20, v3, s[8:11], 0 offen offset:1536
    buffer_load_ushort v21, v3, s[8:11], 0 offen offset:1664
    buffer_load_ushort v22, v3, s[8:11], 0 offen offset:1792
    buffer_load_ushort v23, v3, s[8:11], 0 offen offset:1920
    s_waitcnt vmcnt(0)
    v_lshlrev_b32 v8, 16, v8
    v_lshlrev_b32 v16, 16, v16
    v_lshlrev_b32 v9, 16, v9
    v_lshlrev_b32 v17, 16, v17
    v_lshlrev_b32 v10, 16, v10
    v_lshlrev_b32 v18, 16, v18
    v_lshlrev_b32 v11, 16, v11
    v_lshlrev_b32 v19, 16, v19
    v_lshlrev_b32 v12, 16, v12
    v_lshlrev_b32 v20, 16, v20
    v_lshlrev_b32 v13, 16, v13
    v_lshlrev_b32 v21, 16, v21
    v_lshlrev_b32 v14, 16, v14
    v_lshlrev_b32 v22, 16, v22
    v_lshlrev_b32 v15, 16, v15
    v_lshlrev_b32 v23, 16, v23
    v_add_f32 v24, v8, v9
    v_add_f32 v25, v16, v17
    v_add_f32 v24, v24, v10
    v_add_f32 v25, v25, v18
    v_add_f32 v24, v24, v11
    v_add_f32 v25, v25, v19
    v_add_f32 v24, v24, v12
    v_add_f32 v25, v25, v20
    v_add_f32 v24, v24, v13
    v_add_f32 v25, v25, v21
    v_add_f32 v24, v24, v14
    v_add_f32 v25, v25, v22
    v_add_f32 v24, v24, v15
    v_add_f32 v25, v25, v23
    ds_swizzle_b32 v26, v24 offset:1055
    ds_swizzle_b32 v27, v25 offset:1055
    s_waitcnt lgkmcnt(0)
    v_add_f32 v24, v24, v26
    v_add_f32 v25, v25, v27
    ds_swizzle_b32 v28, v24 offset:2079
    ds_swizzle_b32 v29, v25 offset:2079
    s_waitcnt lgkmcnt(0)
    v_add_f32 v24, v24, v28
    v_add_f32 v25, v25, v29
    ds_swizzle_b32 v30, v24 offset:4127
    ds_swizzle_b32 v31, v25 offset:4127
    s_waitcnt lgkmcnt(0)
    v_add_f32 v24, v24, v30
    v_add_f32 v25, v25, v31
    ds_swizzle_b32 v32, v24 offset:8223
    ds_swizzle_b32 v33, v25 offset:8223
    s_waitcnt lgkmcnt(0)
    v_add_f32 v24, v24, v32
    v_add_f32 v25, v25, v33
    ds_swizzle_b32 v34, v24 offset:16415
    ds_swizzle_b32 v35, v25 offset:16415
    s_waitcnt lgkmcnt(0)
    v_add_f32 v24, v24, v34
    v_add_f32 v25, v25, v35
    ds_bpermute_b32 v36, v4, v24
    ds_bpermute_b32 v37, v4, v25
    s_waitcnt lgkmcnt(0)
    v_add_f32 v24, v24, v36
    v_add_f32 v25, v25, v37
    v_mul_f32 v24, 0x3b000000, v24
    v_mul_f32 v25, 0x3b000000, v25
    v_mov_b32 v38, 0
    v_mov_b32 v39, 0
    v_sub_f32 v40, v8, v24
    v_fma_f32 v38, v40, v40, v38
    v_sub_f32 v40, v16, v25
    v_fma_f32 v39, v40, v40, v39
    v_sub_f32 v40, v9, v24
    v_fma_f32 v38, v40, v40, v38
    v_sub_f32 v40, v17, v25
    v_fma_f32 v39, v40, v40, v39
    v_sub_f32 v40, v10, v24
    v_fma_f32 v38, v40, v40, v38
    v_sub_f32 v40, v18, v25
    v_fma_f32 v39, v40, v40, v39
    v_sub_f32 v40, v11, v24
    v_fma_f32 v38, v40, v40, v38
    v_sub_f32 v40, v19, v25
    v_fma_f32 v39, v40, v40, v39
    v_sub_f32 v40, v12, v24
    v_fma_f32 v38, v40, v40, v38
    v_sub_f32 v40, v20, v25
    v_fma_f32 v39, v40, v40, v39
    v_sub_f32 v40, v13, v24
    v_fma_f32 v38, v40, v40, v38
    v_sub_f32 v40, v21, v25
    v_fma_f32 v39, v40, v40, v39
    v_sub_f32 v40, v14, v24
    v_fma_f32 v38, v40, v40, v38
    v_sub_f32 v40, v22, v25
    v_fma_f32 v39, v40, v40, v39
    v_sub_f32 v40, v15, v24
    v_fma_f32 v38, v40, v40, v38
    v_sub_f32 v40, v23, v25
    v_fma_f32 v39, v40, v40, v39
    ds_swizzle_b32 v41, v38 offset:1055
    ds_swizzle_b32 v42, v39 offset:1055
    s_waitcnt lgkmcnt(0)
    v_add_f32 v38, v38, v41
    v_add_f32 v39, v39, v42
    ds_swizzle_b32 v43, v38 offset:2079
    ds_swizzle_b32 v44, v39 offset:2079
    s_waitcnt lgkmcnt(0)
    v_add_f32 v38, v38, v43
    v_add_f32 v39, v39, v44
    ds_swizzle_b32 v45, v38 offset:4127
    ds_swizzle_b32 v46, v39 offset:4127
    s_waitcnt lgkmcnt(0)
    v_add_f32 v38, v38, v45
    v_add_f32 v39, v39, v46
    ds_swizzle_b32 v47, v38 offset:8223
    ds_swizzle_b32 v48, v39 offset:8223
    s_waitcnt lgkmcnt(0)
    v_add_f32 v38, v38, v47
    v_add_f32 v39, v39, v48
    ds_swizzle_b32 v49, v38 offset:16415
    ds_swizzle_b32 v50, v39 offset:16415
    s_waitcnt lgkmcnt(0)
    v_add_f32 v38, v38, v49
    v_add_f32 v39, v39, v50
    ds_bpermute_b32 v51, v4, v38
    ds_bpermute_b32 v52, v4, v39
    s_waitcnt lgkmcnt(0)
    v_add_f32 v38, v38, v51
    v_add_f32 v39, v39, v52
    v_mul_f32 v38, 0x3b000000, v38
    v_mul_f32 v39, 0x3b000000, v39
    v_cvt_pk_bf16_f32 v53, v24, v25
    v_lshlrev_b32 v24, 16, v53
    v_and_b32 v25, 0xffff0000, v53
    v_cvt_pk_bf16_f32 v54, v38, v39
    v_lshlrev_b32 v38, 16, v54
    v_and_b32 v39, 0xffff0000, v54
    v_add_f32 v38, 0x3727c5ac, v38
    v_add_f32 v39, 0x3727c5ac, v39
    v_cvt_pk_bf16_f32 v55, v38, v39
    v_lshlrev_b32 v38, 16, v55
    v_and_b32 v39, 0xffff0000, v55
    v_sqrt_f32 v38, v38
    v_sqrt_f32 v39, v39
    s_nop 0
    v_cvt_pk_bf16_f32 v56, v38, v39
    v_lshlrev_b32 v38, 16, v56
    v_and_b32 v39, 0xffff0000, v56
    v_rcp_f32 v38, v38
    v_rcp_f32 v39, v39
    v_sub_f32 v8, v8, v24
    v_sub_f32 v16, v16, v25
    v_cvt_pk_bf16_f32 v65, v8, v16
    v_lshlrev_b32 v8, 16, v65
    v_and_b32 v16, 0xffff0000, v65
    v_mul_f32 v8, v8, v38
    v_mul_f32 v16, v16, v39
    v_cvt_pk_bf16_f32 v57, v8, v16
    v_lshlrev_b32 v8, 16, v57
    v_and_b32 v16, 0xffff0000, v57
    v_sub_f32 v9, v9, v24
    v_sub_f32 v17, v17, v25
    v_cvt_pk_bf16_f32 v66, v9, v17
    v_lshlrev_b32 v9, 16, v66
    v_and_b32 v17, 0xffff0000, v66
    v_mul_f32 v9, v9, v38
    v_mul_f32 v17, v17, v39
    v_cvt_pk_bf16_f32 v58, v9, v17
    v_lshlrev_b32 v9, 16, v58
    v_and_b32 v17, 0xffff0000, v58
    v_sub_f32 v10, v10, v24
    v_sub_f32 v18, v18, v25
    v_cvt_pk_bf16_f32 v67, v10, v18
    v_lshlrev_b32 v10, 16, v67
    v_and_b32 v18, 0xffff0000, v67
    v_mul_f32 v10, v10, v38
    v_mul_f32 v18, v18, v39
    v_cvt_pk_bf16_f32 v59, v10, v18
    v_lshlrev_b32 v10, 16, v59
    v_and_b32 v18, 0xffff0000, v59
    v_sub_f32 v11, v11, v24
    v_sub_f32 v19, v19, v25
    v_cvt_pk_bf16_f32 v68, v11, v19
    v_lshlrev_b32 v11, 16, v68
    v_and_b32 v19, 0xffff0000, v68
    v_mul_f32 v11, v11, v38
    v_mul_f32 v19, v19, v39
    v_cvt_pk_bf16_f32 v60, v11, v19
    v_lshlrev_b32 v11, 16, v60
    v_and_b32 v19, 0xffff0000, v60
    v_sub_f32 v12, v12, v24
    v_sub_f32 v20, v20, v25
    v_cvt_pk_bf16_f32 v69, v12, v20
    v_lshlrev_b32 v12, 16, v69
    v_and_b32 v20, 0xffff0000, v69
    v_mul_f32 v12, v12, v38
    v_mul_f32 v20, v20, v39
    v_cvt_pk_bf16_f32 v61, v12, v20
    v_lshlrev_b32 v12, 16, v61
    v_and_b32 v20, 0xffff0000, v61
    v_sub_f32 v13, v13, v24
    v_sub_f32 v21, v21, v25
    v_cvt_pk_bf16_f32 v70, v13, v21
    v_lshlrev_b32 v13, 16, v70
    v_and_b32 v21, 0xffff0000, v70
    v_mul_f32 v13, v13, v38
    v_mul_f32 v21, v21, v39
    v_cvt_pk_bf16_f32 v62, v13, v21
    v_lshlrev_b32 v13, 16, v62
    v_and_b32 v21, 0xffff0000, v62
    v_sub_f32 v14, v14, v24
    v_sub_f32 v22, v22, v25
    v_cvt_pk_bf16_f32 v71, v14, v22
    v_lshlrev_b32 v14, 16, v71
    v_and_b32 v22, 0xffff0000, v71
    v_mul_f32 v14, v14, v38
    v_mul_f32 v22, v22, v39
    v_cvt_pk_bf16_f32 v63, v14, v22
    v_lshlrev_b32 v14, 16, v63
    v_and_b32 v22, 0xffff0000, v63
    v_sub_f32 v15, v15, v24
    v_sub_f32 v23, v23, v25
    v_cvt_pk_bf16_f32 v72, v15, v23
    v_lshlrev_b32 v15, 16, v72
    v_and_b32 v23, 0xffff0000, v72
    v_mul_f32 v15, v15, v38
    v_mul_f32 v23, v23, v39
    v_cvt_pk_bf16_f32 v64, v15, v23
    v_lshlrev_b32 v15, 16, v64
    v_and_b32 v23, 0xffff0000, v64
    v_lshl_add_u32 v73, v1, 3, v5
    v_add_f32 v74, v8, v12
    v_add_f32 v75, v16, v20
    v_sub_f32 v76, v8, v12
    v_sub_f32 v77, v16, v20
    v_add_f32 v78, v9, v13
    v_add_f32 v79, v17, v21
    v_sub_f32 v80, v9, v13
    v_sub_f32 v81, v17, v21
    v_add_f32 v82, v10, v14
    v_add_f32 v83, v18, v22
    v_sub_f32 v84, v10, v14
    v_sub_f32 v85, v18, v22
    v_add_f32 v86, v11, v15
    v_add_f32 v87, v19, v23
    v_sub_f32 v88, v11, v15
    v_sub_f32 v89, v19, v23
    v_add_f32 v90, v80, v81
    v_sub_f32 v91, v81, v80
    v_mul_f32 v90, s16, v90
    v_mul_f32 v91, s16, v91
    v_sub_f32 v92, v89, v88
    v_add_f32 v93, v88, v89
    v_mul_f32 v92, s16, v92
    v_mul_f32_e64 v93, -v93, s16
    v_add_f32 v94, v74, v82
    v_add_f32 v95, v75, v83
    v_sub_f32 v96, v74, v82
    v_sub_f32 v97, v75, v83
    v_add_f32 v98, v78, v86
    v_add_f32 v99, v79, v87
    v_sub_f32 v100, v78, v86
    v_sub_f32 v101, v79, v87
    v_add_f32 v24, v94, v98
    v_add_f32 v25, v95, v99
    v_sub_f32 v32, v94, v98
    v_sub_f32 v33, v95, v99
    v_add_f32 v28, v96, v101
    v_sub_f32 v29, v97, v100
    v_sub_f32 v36, v96, v101
    v_add_f32 v37, v97, v100
    v_add_f32 v102, v76, v85
    v_sub_f32 v103, v77, v84
    v_sub_f32 v104, v76, v85
    v_add_f32 v105, v77, v84
    v_add_f32 v106, v90, v92
    v_add_f32 v107, v91, v93
    v_sub_f32 v108, v90, v92
    v_sub_f32 v109, v91, v93
    v_add_f32 v26, v102, v106
    v_add_f32 v27, v103, v107
    v_sub_f32 v34, v102, v106
    v_sub_f32 v35, v103, v107
    v_add_f32 v30, v104, v109
    v_sub_f32 v31, v105, v108
    v_sub_f32 v38, v104, v109
    v_add_f32 v39, v105, v108
    v_lshl_add_u32 v110, v1, 6, v5
    ds_write_b64 v110, v[24:25] offset:0
    ds_write_b64 v110, v[26:27] offset:8
    ds_write_b64 v110, v[28:29] offset:16
    ds_write_b64 v110, v[30:31] offset:24
    ds_write_b64 v110, v[32:33] offset:32
    ds_write_b64 v110, v[34:35] offset:40
    ds_write_b64 v110, v[36:37] offset:48
    ds_write_b64 v110, v[38:39] offset:56
    s_waitcnt lgkmcnt(0)
    ds_read_b64 v[24:25], v73 offset:0
    ds_read_b64 v[26:27], v73 offset:512
    ds_read_b64 v[28:29], v73 offset:1024
    ds_read_b64 v[30:31], v73 offset:1536
    ds_read_b64 v[32:33], v73 offset:2048
    ds_read_b64 v[34:35], v73 offset:2560
    ds_read_b64 v[36:37], v73 offset:3072
    ds_read_b64 v[38:39], v73 offset:3584
    s_waitcnt lgkmcnt(0)
    v_and_b32 v111, 7, v1
    v_cvt_f32_u32 v112, v111
    v_mul_f32 v112, 0xbc800000, v112
    v_mov_b32 v113, v112
    v_cos_f32 v114, v113
    v_sin_f32 v115, v113
    v_mul_f32 v116, v26, v114
    v_mul_f32 v117, v26, v115
    v_fma_f32 v116, -v27, v115, v116
    v_fma_f32 v117, v27, v114, v117
    v_mul_f32 v118, 0x40000000, v112
    v_cos_f32 v119, v118
    v_sin_f32 v120, v118
    v_mul_f32 v121, v28, v119
    v_mul_f32 v122, v28, v120
    v_fma_f32 v121, -v29, v120, v121
    v_fma_f32 v122, v29, v119, v122
    v_mul_f32 v123, 0x40400000, v112
    v_cos_f32 v124, v123
    v_sin_f32 v125, v123
    v_mul_f32 v126, v30, v124
    v_mul_f32 v127, v30, v125
    v_fma_f32 v126, -v31, v125, v126
    v_fma_f32 v127, v31, v124, v127
    v_mul_f32 v40, 0x40800000, v112
    v_cos_f32 v41, v40
    v_sin_f32 v42, v40
    v_mul_f32 v43, v32, v41
    v_mul_f32 v44, v32, v42
    v_fma_f32 v43, -v33, v42, v43
    v_fma_f32 v44, v33, v41, v44
    v_mul_f32 v45, 0x40a00000, v112
    v_cos_f32 v46, v45
    v_sin_f32 v47, v45
    v_mul_f32 v48, v34, v46
    v_mul_f32 v49, v34, v47
    v_fma_f32 v48, -v35, v47, v48
    v_fma_f32 v49, v35, v46, v49
    v_mul_f32 v50, 0x40c00000, v112
    v_cos_f32 v51, v50
    v_sin_f32 v52, v50
    v_mul_f32 v53, v36, v51
    v_mul_f32 v54, v36, v52
    v_fma_f32 v53, -v37, v52, v53
    v_fma_f32 v54, v37, v51, v54
    v_mul_f32 v55, 0x40e00000, v112
    v_cos_f32 v56, v55
    v_sin_f32 v65, v55
    v_mul_f32 v66, v38, v56
    v_mul_f32 v67, v38, v65
    v_fma_f32 v66, -v39, v65, v66
    v_fma_f32 v67, v39, v56, v67
    v_add_f32 v68, v24, v43
    v_add_f32 v69, v25, v44
    v_sub_f32 v70, v24, v43
    v_sub_f32 v71, v25, v44
    v_add_f32 v72, v116, v48
    v_add_f32 v57, v117, v49
    v_sub_f32 v58, v116, v48
    v_sub_f32 v59, v117, v49
    v_add_f32 v60, v121, v53
    v_add_f32 v61, v122, v54
    v_sub_f32 v62, v121, v53
    v_sub_f32 v63, v122, v54
    v_add_f32 v64, v126, v66
    v_add_f32 v80, v127, v67
    v_sub_f32 v81, v126, v66
    v_sub_f32 v88, v127, v67
    v_add_f32 v89, v58, v59
    v_sub_f32 v74, v59, v58
    v_mul_f32 v89, s16, v89
    v_mul_f32 v74, s16, v74
    v_sub_f32 v75, v88, v81
    v_add_f32 v82, v81, v88
    v_mul_f32 v75, s16, v75
    v_mul_f32_e64 v82, -v82, s16
    v_add_f32 v83, v68, v60
    v_add_f32 v78, v69, v61
    v_sub_f32 v79, v68, v60
    v_sub_f32 v86, v69, v61
    v_add_f32 v87, v72, v64
    v_add_f32 v94, v57, v80
    v_sub_f32 v95, v72, v64
    v_sub_f32 v98, v57, v80
    v_add_f32 v8, v83, v87
    v_add_f32 v9, v78, v94
    v_sub_f32 v16, v83, v87
    v_sub_f32 v17, v78, v94
    v_add_f32 v12, v79, v98
    v_sub_f32 v13, v86, v95
    v_sub_f32 v20, v79, v98
    v_add_f32 v21, v86, v95
    v_add_f32 v99, v70, v63
    v_sub_f32 v96, v71, v62
    v_sub_f32 v97, v70, v63
    v_add_f32 v100, v71, v62
    v_add_f32 v101, v89, v75
    v_add_f32 v76, v74, v82
    v_sub_f32 v77, v89, v75
    v_sub_f32 v84, v74, v82
    v_add_f32 v10, v99, v101
    v_add_f32 v11, v96, v76
    v_sub_f32 v18, v99, v101
    v_sub_f32 v19, v96, v76
    v_add_f32 v14, v97, v84
    v_sub_f32 v15, v100, v77
    v_sub_f32 v22, v97, v84
    v_add_f32 v23, v100, v77
    v_lshrrev_b32 v110, 3, v1
    v_lshl_add_u32 v110, v110, 9, v5
    v_lshl_add_u32 v110, v111, 3, v110
    ds_write_b64 v110, v[8:9] offset:0
    ds_write_b64 v110, v[10:11] offset:64
    ds_write_b64 v110, v[12:13] offset:128
    ds_write_b64 v110, v[14:15] offset:192
    ds_write_b64 v110, v[16:17] offset:256
    ds_write_b64 v110, v[18:19] offset:320
    ds_write_b64 v110, v[20:21] offset:384
    ds_write_b64 v110, v[22:23] offset:448
    s_waitcnt lgkmcnt(0)
    ds_read_b64 v[8:9], v73 offset:0
    ds_read_b64 v[10:11], v73 offset:512
    ds_read_b64 v[12:13], v73 offset:1024
    ds_read_b64 v[14:15], v73 offset:1536
    ds_read_b64 v[16:17], v73 offset:2048
    ds_read_b64 v[18:19], v73 offset:2560
    ds_read_b64 v[20:21], v73 offset:3072
    ds_read_b64 v[22:23], v73 offset:3584
    s_waitcnt lgkmcnt(0)
    v_cvt_f32_u32 v85, v1
    v_mul_f32 v85, 0xbb000000, v85
    v_mov_b32 v90, v85
    v_cos_f32 v91, v90
    v_sin_f32 v92, v90
    v_mul_f32 v93, v10, v91
    v_mul_f32 v102, v10, v92
    v_fma_f32 v93, -v11, v92, v93
    v_fma_f32 v102, v11, v91, v102
    v_mul_f32 v103, 0x40000000, v85
    v_cos_f32 v106, v103
    v_sin_f32 v107, v103
    v_mul_f32 v104, v12, v106
    v_mul_f32 v105, v12, v107
    v_fma_f32 v104, -v13, v107, v104
    v_fma_f32 v105, v13, v106, v105
    v_mul_f32 v108, 0x40400000, v85
    v_cos_f32 v109, v108
    v_sin_f32 v26, v108
    v_mul_f32 v27, v14, v109
    v_mul_f32 v113, v14, v26
    v_fma_f32 v27, -v15, v26, v27
    v_fma_f32 v113, v15, v109, v113
    v_mul_f32 v114, 0x40800000, v85
    v_cos_f32 v115, v114
    v_sin_f32 v28, v114
    v_mul_f32 v29, v16, v115
    v_mul_f32 v118, v16, v28
    v_fma_f32 v29, -v17, v28, v29
    v_fma_f32 v118, v17, v115, v118
    v_mul_f32 v119, 0x40a00000, v85
    v_cos_f32 v120, v119
    v_sin_f32 v30, v119
    v_mul_f32 v31, v18, v120
    v_mul_f32 v123, v18, v30
    v_fma_f32 v31, -v19, v30, v31
    v_fma_f32 v123, v19, v120, v123
    v_mul_f32 v124, 0x40c00000, v85
    v_cos_f32 v125, v124
    v_sin_f32 v32, v124
    v_mul_f32 v33, v20, v125
    v_mul_f32 v40, v20, v32
    v_fma_f32 v33, -v21, v32, v33
    v_fma_f32 v40, v21, v125, v40
    v_mul_f32 v41, 0x40e00000, v85
    v_cos_f32 v42, v41
    v_sin_f32 v34, v41
    v_mul_f32 v35, v22, v42
    v_mul_f32 v45, v22, v34
    v_fma_f32 v35, -v23, v34, v35
    v_fma_f32 v45, v23, v42, v45
    v_add_f32 v46, v8, v29
    v_add_f32 v47, v9, v118
    v_sub_f32 v36, v8, v29
    v_sub_f32 v37, v9, v118
    v_add_f32 v50, v93, v31
    v_add_f32 v51, v102, v123
    v_sub_f32 v52, v93, v31
    v_sub_f32 v38, v102, v123
    v_add_f32 v39, v104, v33
    v_add_f32 v55, v105, v40
    v_sub_f32 v56, v104, v33
    v_sub_f32 v65, v105, v40
    v_add_f32 v112, v27, v35
    v_add_f32 v43, v113, v45
    v_sub_f32 v44, v27, v35
    v_sub_f32 v116, v113, v45
    v_add_f32 v117, v52, v38
    v_sub_f32 v48, v38, v52
    v_mul_f32 v117, s16, v117
    v_mul_f32 v48, s16, v48
    v_sub_f32 v49, v116, v44
    v_add_f32 v121, v44, v116
    v_mul_f32 v49, s16, v49
    v_mul_f32_e64 v121, -v121, s16
    v_add_f32 v122, v46, v39
    v_add_f32 v53, v47, v55
    v_sub_f32 v54, v46, v39
    v_sub_f32 v126, v47, v55
    v_add_f32 v127, v50, v112
    v_add_f32 v66, v51, v43
    v_sub_f32 v67, v50, v112
    v_sub_f32 v58, v51, v43
    v_add_f32 v10, v122, v127
    v_add_f32 v11, v53, v66
    v_sub_f32 v18, v122, v127
    v_sub_f32 v19, v53, v66
    v_add_f32 v14, v54, v58
    v_sub_f32 v15, v126, v67
    v_sub_f32 v22, v54, v58
    v_add_f32 v23, v126, v67
    v_add_f32 v59, v36, v65
    v_sub_f32 v81, v37, v56
    v_sub_f32 v88, v36, v65
    v_add_f32 v68, v37, v56
    v_add_f32 v69, v117, v49
    v_add_f32 v60, v48, v121
    v_sub_f32 v61, v117, v49
    v_sub_f32 v72, v48, v121
    v_add_f32 v12, v59, v69
    v_add_f32 v13, v81, v60
    v_sub_f32 v20, v59, v69
    v_sub_f32 v21, v81, v60
    v_add_f32 v16, v88, v72
    v_sub_f32 v17, v68, v61
    v_sub_f32 v24, v88, v72
    v_add_f32 v25, v68, v61
    ds_write_b64 v73, v[10:11] offset:0
    ds_write_b64 v73, v[12:13] offset:512
    ds_write_b64 v73, v[14:15] offset:1024
    ds_write_b64 v73, v[16:17] offset:1536
    ds_write_b64 v73, v[18:19] offset:2048
    ds_write_b64 v73, v[20:21] offset:2560
    ds_write_b64 v73, v[22:23] offset:3072
    ds_write_b64 v73, v[24:25] offset:3584
    s_waitcnt lgkmcnt(0)
    s_barrier
    v_and_b32 v57, 3, v0
    v_lshrrev_b32 v64, 2, v0
    v_lshlrev_b32 v80, 12, v57
    v_lshlrev_b32 v83, 4, v57
    s_lshl_b32 s17, s2, 6
    v_add_u32 v83, s17, v83
    v_lshl_add_u32 v83, v64, 14, v83
    v_add_u32 v78, 0, v64
    v_lshl_add_u32 v87, v78, 3, v80
    v_sub_u32 v94, 512, v78
    v_and_b32 v94, 511, v94
    v_lshl_add_u32 v94, v94, 3, v80
    ds_read_b64 v[8:9], v87
    ds_read_b64 v[10:11], v94
    s_waitcnt lgkmcnt(0)
    v_add_f32 v12, v8, v10
    v_sub_f32 v13, v9, v11
    v_add_f32 v14, v9, v11
    v_sub_f32 v15, v10, v8
    v_mul_f32 v12, 0.5, v12
    v_mul_f32 v13, 0.5, v13
    v_mul_f32 v14, 0.5, v14
    v_mul_f32 v15, 0.5, v15
    s_mov_b32 s18, 2097152
    buffer_store_dwordx4 v[12:15], v83, s[12:15], s18 offen
    v_add_u32 v79, 64, v64
    v_lshl_add_u32 v86, v79, 3, v80
    v_sub_u32 v95, 512, v79
    v_and_b32 v95, 511, v95
    v_lshl_add_u32 v95, v95, 3, v80
    ds_read_b64 v[8:9], v86
    ds_read_b64 v[10:11], v95
    s_waitcnt lgkmcnt(0)
    v_add_f32 v12, v8, v10
    v_sub_f32 v13, v9, v11
    v_add_f32 v14, v9, v11
    v_sub_f32 v15, v10, v8
    v_mul_f32 v12, 0.5, v12
    v_mul_f32 v13, 0.5, v13
    v_mul_f32 v14, 0.5, v14
    v_mul_f32 v15, 0.5, v15
    s_mov_b32 s18, 3145728
    buffer_store_dwordx4 v[12:15], v83, s[12:15], s18 offen
    v_add_u32 v98, 128, v64
    v_lshl_add_u32 v70, v98, 3, v80
    v_sub_u32 v71, 512, v98
    v_and_b32 v71, 511, v71
    v_lshl_add_u32 v71, v71, 3, v80
    ds_read_b64 v[8:9], v70
    ds_read_b64 v[10:11], v71
    s_waitcnt lgkmcnt(0)
    v_add_f32 v12, v8, v10
    v_sub_f32 v13, v9, v11
    v_add_f32 v14, v9, v11
    v_sub_f32 v15, v10, v8
    v_mul_f32 v12, 0.5, v12
    v_mul_f32 v13, 0.5, v13
    v_mul_f32 v14, 0.5, v14
    v_mul_f32 v15, 0.5, v15
    s_mov_b32 s18, 4194304
    buffer_store_dwordx4 v[12:15], v83, s[12:15], s18 offen
    v_add_u32 v62, 192, v64
    v_lshl_add_u32 v63, v62, 3, v80
    v_sub_u32 v89, 512, v62
    v_and_b32 v89, 511, v89
    v_lshl_add_u32 v89, v89, 3, v80
    ds_read_b64 v[8:9], v63
    ds_read_b64 v[10:11], v89
    s_waitcnt lgkmcnt(0)
    v_add_f32 v12, v8, v10
    v_sub_f32 v13, v9, v11
    v_add_f32 v14, v9, v11
    v_sub_f32 v15, v10, v8
    v_mul_f32 v12, 0.5, v12
    v_mul_f32 v13, 0.5, v13
    v_mul_f32 v14, 0.5, v14
    v_mul_f32 v15, 0.5, v15
    s_mov_b32 s18, 5242880
    buffer_store_dwordx4 v[12:15], v83, s[12:15], s18 offen
    v_cmp_gt_u32 vcc, 4, v0
    s_and_saveexec_b64 s[20:21], vcc
    s_cbranch_execz Lskip256_k1
    v_mov_b32 v74, 256
    v_lshl_add_u32 v75, v74, 3, v80
    v_sub_u32 v82, 512, v74
    v_and_b32 v82, 511, v82
    v_lshl_add_u32 v82, v82, 3, v80
    ds_read_b64 v[8:9], v75
    ds_read_b64 v[10:11], v82
    s_waitcnt lgkmcnt(0)
    v_add_f32 v12, v8, v10
    v_sub_f32 v13, v9, v11
    v_add_f32 v14, v9, v11
    v_sub_f32 v15, v10, v8
    v_mul_f32 v12, 0.5, v12
    v_mul_f32 v13, 0.5, v13
    v_mul_f32 v14, 0.5, v14
    v_mul_f32 v15, 0.5, v15
    v_lshlrev_b32 v99, 4, v57
    v_add_u32 v99, s17, v99
    s_mov_b32 s18, 6291456
    buffer_store_dwordx4 v[12:15], v99, s[12:15], s18 offen
Lskip256_k1:
    s_endpgm
Ltrans_k1:
    s_cmp_ge_u32 s2, 416
    s_cbranch_scc1 Ltrans2_k1
    s_mov_b32 s36, s28
    s_and_b32 s37, s29, 0xffff
    s_mov_b32 s38, 1052672
    s_mov_b32 s39, 0x00020000
    s_mov_b32 s40, s30
    s_and_b32 s41, s31, 0xffff
    s_mov_b32 s42, 1052672
    s_mov_b32 s43, 0x00020000
    s_sub_u32 s20, s2, 256
    s_and_b32 s21, s20, 31
    s_lshr_b32 s22, s20, 5
    s_lshl_b32 s21, s21, 6
    s_lshl_b32 s22, s22, 6
    v_and_b32 v1, 63, v0
    v_lshrrev_b32 v2, 6, v0
    v_lshlrev_b32 v3, 4, v2
    v_add_u32 v3, s21, v3
    s_mov_b32 s23, 514
    v_mul_lo_u32 v3, v3, s23
    v_add_u32 v4, s22, v1
    v_lshl_add_u32 v3, v4, 1, v3
    v_cmp_gt_u32 vcc, 257, v4
    s_mov_b32 s24, 0
    buffer_load_ushort v8, v3, s[36:39], s24 offen
    s_mov_b32 s24, 514
    buffer_load_ushort v9, v3, s[36:39], s24 offen
    s_mov_b32 s24, 1028
    buffer_load_ushort v10, v3, s[36:39], s24 offen
    s_mov_b32 s24, 1542
    buffer_load_ushort v11, v3, s[36:39], s24 offen
    s_mov_b32 s24, 2056
    buffer_load_ushort v12, v3, s[36:39], s24 offen
    s_mov_b32 s24, 2570
    buffer_load_ushort v13, v3, s[36:39], s24 offen
    s_mov_b32 s24, 3084
    buffer_load_ushort v14, v3, s[36:39], s24 offen
    s_mov_b32 s24, 3598
    buffer_load_ushort v15, v3, s[36:39], s24 offen
    s_mov_b32 s24, 4112
    buffer_load_ushort v16, v3, s[36:39], s24 offen
    s_mov_b32 s24, 4626
    buffer_load_ushort v17, v3, s[36:39], s24 offen
    s_mov_b32 s24, 5140
    buffer_load_ushort v18, v3, s[36:39], s24 offen
    s_mov_b32 s24, 5654
    buffer_load_ushort v19, v3, s[36:39], s24 offen
    s_mov_b32 s24, 6168
    buffer_load_ushort v20, v3, s[36:39], s24 offen
    s_mov_b32 s24, 6682
    buffer_load_ushort v21, v3, s[36:39], s24 offen
    s_mov_b32 s24, 7196
    buffer_load_ushort v22, v3, s[36:39], s24 offen
    s_mov_b32 s24, 7710
    buffer_load_ushort v23, v3, s[36:39], s24 offen
    s_mov_b32 s24, 0
    buffer_load_ushort v24, v3, s[40:43], s24 offen
    s_mov_b32 s24, 514
    buffer_load_ushort v25, v3, s[40:43], s24 offen
    s_mov_b32 s24, 1028
    buffer_load_ushort v26, v3, s[40:43], s24 offen
    s_mov_b32 s24, 1542
    buffer_load_ushort v27, v3, s[40:43], s24 offen
    s_mov_b32 s24, 2056
    buffer_load_ushort v28, v3, s[40:43], s24 offen
    s_mov_b32 s24, 2570
    buffer_load_ushort v29, v3, s[40:43], s24 offen
    s_mov_b32 s24, 3084
    buffer_load_ushort v30, v3, s[40:43], s24 offen
    s_mov_b32 s24, 3598
    buffer_load_ushort v31, v3, s[40:43], s24 offen
    s_mov_b32 s24, 4112
    buffer_load_ushort v32, v3, s[40:43], s24 offen
    s_mov_b32 s24, 4626
    buffer_load_ushort v33, v3, s[40:43], s24 offen
    s_mov_b32 s24, 5140
    buffer_load_ushort v34, v3, s[40:43], s24 offen
    s_mov_b32 s24, 5654
    buffer_load_ushort v35, v3, s[40:43], s24 offen
    s_mov_b32 s24, 6168
    buffer_load_ushort v36, v3, s[40:43], s24 offen
    s_mov_b32 s24, 6682
    buffer_load_ushort v37, v3, s[40:43], s24 offen
    s_mov_b32 s24, 7196
    buffer_load_ushort v38, v3, s[40:43], s24 offen
    s_mov_b32 s24, 7710
    buffer_load_ushort v39, v3, s[40:43], s24 offen
    s_waitcnt vmcnt(0)
    v_cndmask_b32 v8, 0, v8, vcc
    v_cndmask_b32 v9, 0, v9, vcc
    v_cndmask_b32 v10, 0, v10, vcc
    v_cndmask_b32 v11, 0, v11, vcc
    v_cndmask_b32 v12, 0, v12, vcc
    v_cndmask_b32 v13, 0, v13, vcc
    v_cndmask_b32 v14, 0, v14, vcc
    v_cndmask_b32 v15, 0, v15, vcc
    v_cndmask_b32 v16, 0, v16, vcc
    v_cndmask_b32 v17, 0, v17, vcc
    v_cndmask_b32 v18, 0, v18, vcc
    v_cndmask_b32 v19, 0, v19, vcc
    v_cndmask_b32 v20, 0, v20, vcc
    v_cndmask_b32 v21, 0, v21, vcc
    v_cndmask_b32 v22, 0, v22, vcc
    v_cndmask_b32 v23, 0, v23, vcc
    v_cndmask_b32 v24, 0, v24, vcc
    v_cndmask_b32 v25, 0, v25, vcc
    v_cndmask_b32 v26, 0, v26, vcc
    v_cndmask_b32 v27, 0, v27, vcc
    v_cndmask_b32 v28, 0, v28, vcc
    v_cndmask_b32 v29, 0, v29, vcc
    v_cndmask_b32 v30, 0, v30, vcc
    v_cndmask_b32 v31, 0, v31, vcc
    v_cndmask_b32 v32, 0, v32, vcc
    v_cndmask_b32 v33, 0, v33, vcc
    v_cndmask_b32 v34, 0, v34, vcc
    v_cndmask_b32 v35, 0, v35, vcc
    v_cndmask_b32 v36, 0, v36, vcc
    v_cndmask_b32 v37, 0, v37, vcc
    v_cndmask_b32 v38, 0, v38, vcc
    v_cndmask_b32 v39, 0, v39, vcc
    v_lshl_or_b32 v8, v24, 16, v8
    v_lshl_or_b32 v9, v25, 16, v9
    v_lshl_or_b32 v10, v26, 16, v10
    v_lshl_or_b32 v11, v27, 16, v11
    v_lshl_or_b32 v12, v28, 16, v12
    v_lshl_or_b32 v13, v29, 16, v13
    v_lshl_or_b32 v14, v30, 16, v14
    v_lshl_or_b32 v15, v31, 16, v15
    v_lshl_or_b32 v16, v32, 16, v16
    v_lshl_or_b32 v17, v33, 16, v17
    v_lshl_or_b32 v18, v34, 16, v18
    v_lshl_or_b32 v19, v35, 16, v19
    v_lshl_or_b32 v20, v36, 16, v20
    v_lshl_or_b32 v21, v37, 16, v21
    v_lshl_or_b32 v22, v38, 16, v22
    v_lshl_or_b32 v23, v39, 16, v23
    v_mul_u32_u24 v5, 65, v1
    v_lshl_add_u32 v5, v2, 4, v5
    v_lshlrev_b32 v5, 2, v5
    ds_write_b32 v5, v8 offset:0
    ds_write_b32 v5, v9 offset:4
    ds_write_b32 v5, v10 offset:8
    ds_write_b32 v5, v11 offset:12
    ds_write_b32 v5, v12 offset:16
    ds_write_b32 v5, v13 offset:20
    ds_write_b32 v5, v14 offset:24
    ds_write_b32 v5, v15 offset:28
    ds_write_b32 v5, v16 offset:32
    ds_write_b32 v5, v17 offset:36
    ds_write_b32 v5, v18 offset:40
    ds_write_b32 v5, v19 offset:44
    ds_write_b32 v5, v20 offset:48
    ds_write_b32 v5, v21 offset:52
    ds_write_b32 v5, v22 offset:56
    ds_write_b32 v5, v23 offset:60
    s_waitcnt lgkmcnt(0)
    s_barrier
    v_mul_u32_u24 v6, 65, v2
    v_lshlrev_b32 v6, 4, v6
    v_add_u32 v6, v6, v1
    v_lshlrev_b32 v6, 2, v6
    ds_read_b32 v8, v6 offset:0
    ds_read_b32 v9, v6 offset:260
    ds_read_b32 v10, v6 offset:520
    ds_read_b32 v11, v6 offset:780
    ds_read_b32 v12, v6 offset:1040
    ds_read_b32 v13, v6 offset:1300
    ds_read_b32 v14, v6 offset:1560
    ds_read_b32 v15, v6 offset:1820
    ds_read_b32 v16, v6 offset:2080
    ds_read_b32 v17, v6 offset:2340
    ds_read_b32 v18, v6 offset:2600
    ds_read_b32 v19, v6 offset:2860
    ds_read_b32 v20, v6 offset:3120
    ds_read_b32 v21, v6 offset:3380
    ds_read_b32 v22, v6 offset:3640
    ds_read_b32 v23, v6 offset:3900
    v_lshlrev_b32 v7, 4, v2
    v_add_u32 v7, s22, v7
    s_mov_b32 s23, 2048
    v_mul_lo_u32 v7, v7, s23
    v_add_u32 v7, v7, v1
    v_add_u32 v7, s21, v7
    v_lshlrev_b32 v7, 2, v7
    s_waitcnt lgkmcnt(0)
    v_readfirstlane_b32 s25, v2
    s_lshl_b32 s25, s25, 4
    s_add_u32 s25, s25, s22
    s_add_u32 s26, s25, 0
    s_cmp_ge_u32 s26, 257
    s_cbranch_scc1 Ltdw_k1_1
    s_mov_b32 s24, 14680064
    buffer_store_dword v8, v7, s[12:15], s24 offen
    s_add_u32 s26, s25, 1
    s_cmp_ge_u32 s26, 257
    s_cbranch_scc1 Ltdw_k1_1
    s_mov_b32 s24, 14688256
    buffer_store_dword v9, v7, s[12:15], s24 offen
    s_add_u32 s26, s25, 2
    s_cmp_ge_u32 s26, 257
    s_cbranch_scc1 Ltdw_k1_1
    s_mov_b32 s24, 14696448
    buffer_store_dword v10, v7, s[12:15], s24 offen
    s_add_u32 s26, s25, 3
    s_cmp_ge_u32 s26, 257
    s_cbranch_scc1 Ltdw_k1_1
    s_mov_b32 s24, 14704640
    buffer_store_dword v11, v7, s[12:15], s24 offen
    s_add_u32 s26, s25, 4
    s_cmp_ge_u32 s26, 257
    s_cbranch_scc1 Ltdw_k1_1
    s_mov_b32 s24, 14712832
    buffer_store_dword v12, v7, s[12:15], s24 offen
    s_add_u32 s26, s25, 5
    s_cmp_ge_u32 s26, 257
    s_cbranch_scc1 Ltdw_k1_1
    s_mov_b32 s24, 14721024
    buffer_store_dword v13, v7, s[12:15], s24 offen
    s_add_u32 s26, s25, 6
    s_cmp_ge_u32 s26, 257
    s_cbranch_scc1 Ltdw_k1_1
    s_mov_b32 s24, 14729216
    buffer_store_dword v14, v7, s[12:15], s24 offen
    s_add_u32 s26, s25, 7
    s_cmp_ge_u32 s26, 257
    s_cbranch_scc1 Ltdw_k1_1
    s_mov_b32 s24, 14737408
    buffer_store_dword v15, v7, s[12:15], s24 offen
    s_add_u32 s26, s25, 8
    s_cmp_ge_u32 s26, 257
    s_cbranch_scc1 Ltdw_k1_1
    s_mov_b32 s24, 14745600
    buffer_store_dword v16, v7, s[12:15], s24 offen
    s_add_u32 s26, s25, 9
    s_cmp_ge_u32 s26, 257
    s_cbranch_scc1 Ltdw_k1_1
    s_mov_b32 s24, 14753792
    buffer_store_dword v17, v7, s[12:15], s24 offen
    s_add_u32 s26, s25, 10
    s_cmp_ge_u32 s26, 257
    s_cbranch_scc1 Ltdw_k1_1
    s_mov_b32 s24, 14761984
    buffer_store_dword v18, v7, s[12:15], s24 offen
    s_add_u32 s26, s25, 11
    s_cmp_ge_u32 s26, 257
    s_cbranch_scc1 Ltdw_k1_1
    s_mov_b32 s24, 14770176
    buffer_store_dword v19, v7, s[12:15], s24 offen
    s_add_u32 s26, s25, 12
    s_cmp_ge_u32 s26, 257
    s_cbranch_scc1 Ltdw_k1_1
    s_mov_b32 s24, 14778368
    buffer_store_dword v20, v7, s[12:15], s24 offen
    s_add_u32 s26, s25, 13
    s_cmp_ge_u32 s26, 257
    s_cbranch_scc1 Ltdw_k1_1
    s_mov_b32 s24, 14786560
    buffer_store_dword v21, v7, s[12:15], s24 offen
    s_add_u32 s26, s25, 14
    s_cmp_ge_u32 s26, 257
    s_cbranch_scc1 Ltdw_k1_1
    s_mov_b32 s24, 14794752
    buffer_store_dword v22, v7, s[12:15], s24 offen
    s_add_u32 s26, s25, 15
    s_cmp_ge_u32 s26, 257
    s_cbranch_scc1 Ltdw_k1_1
    s_mov_b32 s24, 14802944
    buffer_store_dword v23, v7, s[12:15], s24 offen
Ltdw_k1_1:
    s_endpgm
Ltrans2_k1:
Lend_k1:
    s_endpgm
Lend_l1:
    s_endpgm
.globl l2_kernel
.p2align 8
.type l2_kernel,@function
l2_kernel:
    s_cmp_ge_u32 s2, 385
    s_cbranch_scc1 Lend_l2
    s_cmp_lt_u32 s2, 128
    s_cbranch_scc1 Lrole_l2_0
    s_branch Lrole_l2_1
Lrole_l2_0:
    s_cmp_ge_u32 s2, 128
    s_cbranch_scc1 Lend_g2
    s_load_dwordx2 s[6:7], s[0:1], 64
    s_load_dwordx2 s[4:5], s[0:1], 40
    s_waitcnt lgkmcnt(0)
    s_mov_b32 s12, s6
    s_and_b32 s13, s7, 0xffff
    s_mov_b32 s14, 268435456
    s_mov_b32 s15, 0x00020000
    s_mov_b32 s8, s4
    s_and_b32 s9, s5, 0xffff
    s_mov_b32 s10, 1409024
    s_mov_b32 s11, 0x00020000
    s_and_b32 s20, s2, 31
    s_lshr_b32 s21, s2, 5
    v_lshrrev_b32 v1, 6, v0
    v_and_b32 v2, 63, v0
    v_readfirstlane_b32 s30, v1
    v_lshrrev_b32 v3, 2, v2
    v_and_b32 v4, 3, v2
    v_bfe_u32 v5, v2, 4, 2
    v_xor_b32 v4, v4, v5
    s_mov_b32 s24, 2816
    s_mul_i32 s22, s20, 180224
    s_mul_i32 s25, s30, 45056
    s_add_u32 s22, s22, s25
    v_add_u32 v6, 0, v3
    v_mul_lo_u32 v6, v6, s24
    v_lshl_add_u32 v6, v4, 4, v6
    v_add_u32 v10, s22, v6
    v_lshrrev_b32 v3, 4, v2
    v_and_b32 v4, 15, v2
    v_and_b32 v5, 3, v3
    v_lshlrev_b32 v5, 2, v5
    v_xor_b32 v4, v4, v5
    s_mov_b32 s24, 1024
    s_mul_i32 s23, s21, 256
    s_mul_i32 s25, s30, 8192
    s_add_u32 s23, s23, s25
    v_add_u32 v6, 0, v3
    v_mul_lo_u32 v6, v6, s24
    v_lshl_add_u32 v6, v4, 4, v6
    v_add_u32 v12, s23, v6
    v_add_u32 v6, 4, v3
    v_mul_lo_u32 v6, v6, s24
    v_lshl_add_u32 v6, v4, 4, v6
    v_add_u32 v13, s23, v6
    s_mul_i32 s31, s30, 1024
    s_mul_i32 s32, s30, 2048
    s_add_u32 s32, s32, 4096
    v_mov_b32 v3, 0
    v_mov_b32 v4, v1
    v_and_b32 v5, 31, v2
    v_lshrrev_b32 v6, 5, v2
    v_mul_u32_u24 v7, 64, v3
    v_add_u32 v7, v7, v5
    v_lshlrev_b32 v7, 6, v7
    v_bfe_u32 v8, v5, 2, 2
    v_add_u32 v9, 0, v6
    v_xor_b32 v9, v9, v8
    v_lshl_add_u32 v14, v9, 4, v7
    v_add_u32 v9, 2, v6
    v_xor_b32 v9, v9, v8
    v_lshl_add_u32 v15, v9, 4, v7
    v_bfe_u32 v7, v2, 2, 2
    v_lshl_add_u32 v8, v6, 3, v7
    v_lshlrev_b32 v8, 8, v8
    v_bfe_u32 v9, v2, 4, 1
    v_lshl_add_u32 v8, v9, 5, v8
    v_and_b32 v9, 3, v2
    v_lshl_add_u32 v8, v9, 3, v8
    v_add_u32 v8, 4096, v8
    v_mul_u32_u24 v9, 1, v4
    v_add_u32 v9, 0, v9
    v_xor_b32 v9, v9, v7
    v_lshl_add_u32 v16, v9, 6, v8
    v_mov_b32 v48, 0
    v_mov_b32 v49, 0
    v_mov_b32 v50, 0
    v_mov_b32 v51, 0
    v_mov_b32 v52, 0
    v_mov_b32 v53, 0
    v_mov_b32 v54, 0
    v_mov_b32 v55, 0
    v_mov_b32 v56, 0
    v_mov_b32 v57, 0
    v_mov_b32 v58, 0
    v_mov_b32 v59, 0
    v_mov_b32 v60, 0
    v_mov_b32 v61, 0
    v_mov_b32 v62, 0
    v_mov_b32 v63, 0
    v_mov_b32 v64, 0
    v_mov_b32 v65, 0
    v_mov_b32 v66, 0
    v_mov_b32 v67, 0
    v_mov_b32 v68, 0
    v_mov_b32 v69, 0
    v_mov_b32 v70, 0
    v_mov_b32 v71, 0
    v_mov_b32 v72, 0
    v_mov_b32 v73, 0
    v_mov_b32 v74, 0
    v_mov_b32 v75, 0
    v_mov_b32 v76, 0
    v_mov_b32 v77, 0
    v_mov_b32 v78, 0
    v_mov_b32 v79, 0
    s_add_u32 m0, s31, 0
    s_mov_b32 s26, 22020096
    buffer_load_dwordx4 v10, s[12:15], s26 offen lds
    s_add_u32 m0, s32, 0
    s_mov_b32 s26, 0
    buffer_load_dwordx4 v12, s[8:11], s26 offen lds
    s_add_u32 m0, s32, 1024
    s_mov_b32 s26, 0
    buffer_load_dwordx4 v13, s[8:11], s26 offen lds
    s_add_u32 m0, s31, 12288
    s_mov_b32 s26, 22020160
    buffer_load_dwordx4 v10, s[12:15], s26 offen lds
    s_add_u32 m0, s32, 12288
    s_mov_b32 s26, 32768
    buffer_load_dwordx4 v12, s[8:11], s26 offen lds
    s_add_u32 m0, s32, 13312
    s_mov_b32 s26, 32768
    buffer_load_dwordx4 v13, s[8:11], s26 offen lds
    s_add_u32 m0, s31, 24576
    s_mov_b32 s26, 22020224
    buffer_load_dwordx4 v10, s[12:15], s26 offen lds
    s_add_u32 m0, s32, 24576
    s_mov_b32 s26, 65536
    buffer_load_dwordx4 v12, s[8:11], s26 offen lds
    s_add_u32 m0, s32, 25600
    s_mov_b32 s26, 65536
    buffer_load_dwordx4 v13, s[8:11], s26 offen lds
    s_waitcnt vmcnt(6)
    s_barrier
    s_add_u32 m0, s31, 36864
    s_mov_b32 s26, 22020288
    buffer_load_dwordx4 v10, s[12:15], s26 offen lds
    s_add_u32 m0, s32, 36864
    s_mov_b32 s26, 98304
    buffer_load_dwordx4 v12, s[8:11], s26 offen lds
    s_add_u32 m0, s32, 37888
    s_mov_b32 s26, 98304
    buffer_load_dwordx4 v13, s[8:11], s26 offen lds
    ds_read_b128 v[24:27], v14 offset:0
    ds_read_b128 v[28:31], v14 offset:2048
    ds_read_b64_tr_b16 v[32:33], v16 offset:0
    ds_read_b64_tr_b16 v[34:35], v16 offset:1024
    ds_read_b128 v[36:39], v15 offset:0
    ds_read_b128 v[40:43], v15 offset:2048
    ds_read_b64_tr_b16 v[44:45], v16 offset:4096
    ds_read_b64_tr_b16 v[46:47], v16 offset:5120
    s_waitcnt lgkmcnt(4)
    v_mfma_f32_32x32x16_bf16 v[48:63], v[32:35], v[24:27], v[48:63]
    v_mfma_f32_32x32x16_bf16 v[64:79], v[32:35], v[28:31], v[64:79]
    s_waitcnt lgkmcnt(0)
    v_mfma_f32_32x32x16_bf16 v[48:63], v[44:47], v[36:39], v[48:63]
    v_mfma_f32_32x32x16_bf16 v[64:79], v[44:47], v[40:43], v[64:79]
    s_waitcnt vmcnt(6)
    s_barrier
    s_add_u32 m0, s31, 0
    s_mov_b32 s26, 22020352
    buffer_load_dwordx4 v10, s[12:15], s26 offen lds
    s_add_u32 m0, s32, 0
    s_mov_b32 s26, 131072
    buffer_load_dwordx4 v12, s[8:11], s26 offen lds
    s_add_u32 m0, s32, 1024
    s_mov_b32 s26, 131072
    buffer_load_dwordx4 v13, s[8:11], s26 offen lds
    ds_read_b128 v[24:27], v14 offset:12288
    ds_read_b128 v[28:31], v14 offset:14336
    ds_read_b64_tr_b16 v[32:33], v16 offset:12288
    ds_read_b64_tr_b16 v[34:35], v16 offset:13312
    ds_read_b128 v[36:39], v15 offset:12288
    ds_read_b128 v[40:43], v15 offset:14336
    ds_read_b64_tr_b16 v[44:45], v16 offset:16384
    ds_read_b64_tr_b16 v[46:47], v16 offset:17408
    s_waitcnt lgkmcnt(4)
    v_mfma_f32_32x32x16_bf16 v[48:63], v[32:35], v[24:27], v[48:63]
    v_mfma_f32_32x32x16_bf16 v[64:79], v[32:35], v[28:31], v[64:79]
    s_waitcnt lgkmcnt(0)
    v_mfma_f32_32x32x16_bf16 v[48:63], v[44:47], v[36:39], v[48:63]
    v_mfma_f32_32x32x16_bf16 v[64:79], v[44:47], v[40:43], v[64:79]
    s_waitcnt vmcnt(6)
    s_barrier
    s_add_u32 m0, s31, 12288
    s_mov_b32 s26, 22020416
    buffer_load_dwordx4 v10, s[12:15], s26 offen lds
    s_add_u32 m0, s32, 12288
    s_mov_b32 s26, 163840
    buffer_load_dwordx4 v12, s[8:11], s26 offen lds
    s_add_u32 m0, s32, 13312
    s_mov_b32 s26, 163840
    buffer_load_dwordx4 v13, s[8:11], s26 offen lds
    ds_read_b128 v[24:27], v14 offset:24576
    ds_read_b128 v[28:31], v14 offset:26624
    ds_read_b64_tr_b16 v[32:33], v16 offset:24576
    ds_read_b64_tr_b16 v[34:35], v16 offset:25600
    ds_read_b128 v[36:39], v15 offset:24576
    ds_read_b128 v[40:43], v15 offset:26624
    ds_read_b64_tr_b16 v[44:45], v16 offset:28672
    ds_read_b64_tr_b16 v[46:47], v16 offset:29696
    s_waitcnt lgkmcnt(4)
    v_mfma_f32_32x32x16_bf16 v[48:63], v[32:35], v[24:27], v[48:63]
    v_mfma_f32_32x32x16_bf16 v[64:79], v[32:35], v[28:31], v[64:79]
    s_waitcnt lgkmcnt(0)
    v_mfma_f32_32x32x16_bf16 v[48:63], v[44:47], v[36:39], v[48:63]
    v_mfma_f32_32x32x16_bf16 v[64:79], v[44:47], v[40:43], v[64:79]
    s_waitcnt vmcnt(6)
    s_barrier
    s_add_u32 m0, s31, 24576
    s_mov_b32 s26, 22020480
    buffer_load_dwordx4 v10, s[12:15], s26 offen lds
    s_add_u32 m0, s32, 24576
    s_mov_b32 s26, 196608
    buffer_load_dwordx4 v12, s[8:11], s26 offen lds
    s_add_u32 m0, s32, 25600
    s_mov_b32 s26, 196608
    buffer_load_dwordx4 v13, s[8:11], s26 offen lds
    ds_read_b128 v[24:27], v14 offset:36864
    ds_read_b128 v[28:31], v14 offset:38912
    ds_read_b64_tr_b16 v[32:33], v16 offset:36864
    ds_read_b64_tr_b16 v[34:35], v16 offset:37888
    ds_read_b128 v[36:39], v15 offset:36864
    ds_read_b128 v[40:43], v15 offset:38912
    ds_read_b64_tr_b16 v[44:45], v16 offset:40960
    ds_read_b64_tr_b16 v[46:47], v16 offset:41984
    s_waitcnt lgkmcnt(4)
    v_mfma_f32_32x32x16_bf16 v[48:63], v[32:35], v[24:27], v[48:63]
    v_mfma_f32_32x32x16_bf16 v[64:79], v[32:35], v[28:31], v[64:79]
    s_waitcnt lgkmcnt(0)
    v_mfma_f32_32x32x16_bf16 v[48:63], v[44:47], v[36:39], v[48:63]
    v_mfma_f32_32x32x16_bf16 v[64:79], v[44:47], v[40:43], v[64:79]
    s_waitcnt vmcnt(6)
    s_barrier
    s_add_u32 m0, s31, 36864
    s_mov_b32 s26, 22020544
    buffer_load_dwordx4 v10, s[12:15], s26 offen lds
    s_add_u32 m0, s32, 36864
    s_mov_b32 s26, 229376
    buffer_load_dwordx4 v12, s[8:11], s26 offen lds
    s_add_u32 m0, s32, 37888
    s_mov_b32 s26, 229376
    buffer_load_dwordx4 v13, s[8:11], s26 offen lds
    ds_read_b128 v[24:27], v14 offset:0
    ds_read_b128 v[28:31], v14 offset:2048
    ds_read_b64_tr_b16 v[32:33], v16 offset:0
    ds_read_b64_tr_b16 v[34:35], v16 offset:1024
    ds_read_b128 v[36:39], v15 offset:0
    ds_read_b128 v[40:43], v15 offset:2048
    ds_read_b64_tr_b16 v[44:45], v16 offset:4096
    ds_read_b64_tr_b16 v[46:47], v16 offset:5120
    s_waitcnt lgkmcnt(4)
    v_mfma_f32_32x32x16_bf16 v[48:63], v[32:35], v[24:27], v[48:63]
    v_mfma_f32_32x32x16_bf16 v[64:79], v[32:35], v[28:31], v[64:79]
    s_waitcnt lgkmcnt(0)
    v_mfma_f32_32x32x16_bf16 v[48:63], v[44:47], v[36:39], v[48:63]
    v_mfma_f32_32x32x16_bf16 v[64:79], v[44:47], v[40:43], v[64:79]
    s_waitcnt vmcnt(6)
    s_barrier
    s_add_u32 m0, s31, 0
    s_mov_b32 s26, 22020608
    buffer_load_dwordx4 v10, s[12:15], s26 offen lds
    s_add_u32 m0, s32, 0
    s_mov_b32 s26, 262144
    buffer_load_dwordx4 v12, s[8:11], s26 offen lds
    s_add_u32 m0, s32, 1024
    s_mov_b32 s26, 262144
    buffer_load_dwordx4 v13, s[8:11], s26 offen lds
    ds_read_b128 v[24:27], v14 offset:12288
    ds_read_b128 v[28:31], v14 offset:14336
    ds_read_b64_tr_b16 v[32:33], v16 offset:12288
    ds_read_b64_tr_b16 v[34:35], v16 offset:13312
    ds_read_b128 v[36:39], v15 offset:12288
    ds_read_b128 v[40:43], v15 offset:14336
    ds_read_b64_tr_b16 v[44:45], v16 offset:16384
    ds_read_b64_tr_b16 v[46:47], v16 offset:17408
    s_waitcnt lgkmcnt(4)
    v_mfma_f32_32x32x16_bf16 v[48:63], v[32:35], v[24:27], v[48:63]
    v_mfma_f32_32x32x16_bf16 v[64:79], v[32:35], v[28:31], v[64:79]
    s_waitcnt lgkmcnt(0)
    v_mfma_f32_32x32x16_bf16 v[48:63], v[44:47], v[36:39], v[48:63]
    v_mfma_f32_32x32x16_bf16 v[64:79], v[44:47], v[40:43], v[64:79]
    s_waitcnt vmcnt(6)
    s_barrier
    s_add_u32 m0, s31, 12288
    s_mov_b32 s26, 22020672
    buffer_load_dwordx4 v10, s[12:15], s26 offen lds
    s_add_u32 m0, s32, 12288
    s_mov_b32 s26, 294912
    buffer_load_dwordx4 v12, s[8:11], s26 offen lds
    s_add_u32 m0, s32, 13312
    s_mov_b32 s26, 294912
    buffer_load_dwordx4 v13, s[8:11], s26 offen lds
    ds_read_b128 v[24:27], v14 offset:24576
    ds_read_b128 v[28:31], v14 offset:26624
    ds_read_b64_tr_b16 v[32:33], v16 offset:24576
    ds_read_b64_tr_b16 v[34:35], v16 offset:25600
    ds_read_b128 v[36:39], v15 offset:24576
    ds_read_b128 v[40:43], v15 offset:26624
    ds_read_b64_tr_b16 v[44:45], v16 offset:28672
    ds_read_b64_tr_b16 v[46:47], v16 offset:29696
    s_waitcnt lgkmcnt(4)
    v_mfma_f32_32x32x16_bf16 v[48:63], v[32:35], v[24:27], v[48:63]
    v_mfma_f32_32x32x16_bf16 v[64:79], v[32:35], v[28:31], v[64:79]
    s_waitcnt lgkmcnt(0)
    v_mfma_f32_32x32x16_bf16 v[48:63], v[44:47], v[36:39], v[48:63]
    v_mfma_f32_32x32x16_bf16 v[64:79], v[44:47], v[40:43], v[64:79]
    s_waitcnt vmcnt(6)
    s_barrier
    s_add_u32 m0, s31, 24576
    s_mov_b32 s26, 22020736
    buffer_load_dwordx4 v10, s[12:15], s26 offen lds
    s_add_u32 m0, s32, 24576
    s_mov_b32 s26, 327680
    buffer_load_dwordx4 v12, s[8:11], s26 offen lds
    s_add_u32 m0, s32, 25600
    s_mov_b32 s26, 327680
    buffer_load_dwordx4 v13, s[8:11], s26 offen lds
    ds_read_b128 v[24:27], v14 offset:36864
    ds_read_b128 v[28:31], v14 offset:38912
    ds_read_b64_tr_b16 v[32:33], v16 offset:36864
    ds_read_b64_tr_b16 v[34:35], v16 offset:37888
    ds_read_b128 v[36:39], v15 offset:36864
    ds_read_b128 v[40:43], v15 offset:38912
    ds_read_b64_tr_b16 v[44:45], v16 offset:40960
    ds_read_b64_tr_b16 v[46:47], v16 offset:41984
    s_waitcnt lgkmcnt(4)
    v_mfma_f32_32x32x16_bf16 v[48:63], v[32:35], v[24:27], v[48:63]
    v_mfma_f32_32x32x16_bf16 v[64:79], v[32:35], v[28:31], v[64:79]
    s_waitcnt lgkmcnt(0)
    v_mfma_f32_32x32x16_bf16 v[48:63], v[44:47], v[36:39], v[48:63]
    v_mfma_f32_32x32x16_bf16 v[64:79], v[44:47], v[40:43], v[64:79]
    s_waitcnt vmcnt(6)
    s_barrier
    s_add_u32 m0, s31, 36864
    s_mov_b32 s26, 22020800
    buffer_load_dwordx4 v10, s[12:15], s26 offen lds
    s_add_u32 m0, s32, 36864
    s_mov_b32 s26, 360448
    buffer_load_dwordx4 v12, s[8:11], s26 offen lds
    s_add_u32 m0, s32, 37888
    s_mov_b32 s26, 360448
    buffer_load_dwordx4 v13, s[8:11], s26 offen lds
    ds_read_b128 v[24:27], v14 offset:0
    ds_read_b128 v[28:31], v14 offset:2048
    ds_read_b64_tr_b16 v[32:33], v16 offset:0
    ds_read_b64_tr_b16 v[34:35], v16 offset:1024
    ds_read_b128 v[36:39], v15 offset:0
    ds_read_b128 v[40:43], v15 offset:2048
    ds_read_b64_tr_b16 v[44:45], v16 offset:4096
    ds_read_b64_tr_b16 v[46:47], v16 offset:5120
    s_waitcnt lgkmcnt(4)
    v_mfma_f32_32x32x16_bf16 v[48:63], v[32:35], v[24:27], v[48:63]
    v_mfma_f32_32x32x16_bf16 v[64:79], v[32:35], v[28:31], v[64:79]
    s_waitcnt lgkmcnt(0)
    v_mfma_f32_32x32x16_bf16 v[48:63], v[44:47], v[36:39], v[48:63]
    v_mfma_f32_32x32x16_bf16 v[64:79], v[44:47], v[40:43], v[64:79]
    s_waitcnt vmcnt(6)
    s_barrier
    s_add_u32 m0, s31, 0
    s_mov_b32 s26, 22020864
    buffer_load_dwordx4 v10, s[12:15], s26 offen lds
    s_add_u32 m0, s32, 0
    s_mov_b32 s26, 393216
    buffer_load_dwordx4 v12, s[8:11], s26 offen lds
    s_add_u32 m0, s32, 1024
    s_mov_b32 s26, 393216
    buffer_load_dwordx4 v13, s[8:11], s26 offen lds
    ds_read_b128 v[24:27], v14 offset:12288
    ds_read_b128 v[28:31], v14 offset:14336
    ds_read_b64_tr_b16 v[32:33], v16 offset:12288
    ds_read_b64_tr_b16 v[34:35], v16 offset:13312
    ds_read_b128 v[36:39], v15 offset:12288
    ds_read_b128 v[40:43], v15 offset:14336
    ds_read_b64_tr_b16 v[44:45], v16 offset:16384
    ds_read_b64_tr_b16 v[46:47], v16 offset:17408
    s_waitcnt lgkmcnt(4)
    v_mfma_f32_32x32x16_bf16 v[48:63], v[32:35], v[24:27], v[48:63]
    v_mfma_f32_32x32x16_bf16 v[64:79], v[32:35], v[28:31], v[64:79]
    s_waitcnt lgkmcnt(0)
    v_mfma_f32_32x32x16_bf16 v[48:63], v[44:47], v[36:39], v[48:63]
    v_mfma_f32_32x32x16_bf16 v[64:79], v[44:47], v[40:43], v[64:79]
    s_waitcnt vmcnt(6)
    s_barrier
    s_add_u32 m0, s31, 12288
    s_mov_b32 s26, 22020928
    buffer_load_dwordx4 v10, s[12:15], s26 offen lds
    s_add_u32 m0, s32, 12288
    s_mov_b32 s26, 425984
    buffer_load_dwordx4 v12, s[8:11], s26 offen lds
    s_add_u32 m0, s32, 13312
    s_mov_b32 s26, 425984
    buffer_load_dwordx4 v13, s[8:11], s26 offen lds
    ds_read_b128 v[24:27], v14 offset:24576
    ds_read_b128 v[28:31], v14 offset:26624
    ds_read_b64_tr_b16 v[32:33], v16 offset:24576
    ds_read_b64_tr_b16 v[34:35], v16 offset:25600
    ds_read_b128 v[36:39], v15 offset:24576
    ds_read_b128 v[40:43], v15 offset:26624
    ds_read_b64_tr_b16 v[44:45], v16 offset:28672
    ds_read_b64_tr_b16 v[46:47], v16 offset:29696
    s_waitcnt lgkmcnt(4)
    v_mfma_f32_32x32x16_bf16 v[48:63], v[32:35], v[24:27], v[48:63]
    v_mfma_f32_32x32x16_bf16 v[64:79], v[32:35], v[28:31], v[64:79]
    s_waitcnt lgkmcnt(0)
    v_mfma_f32_32x32x16_bf16 v[48:63], v[44:47], v[36:39], v[48:63]
    v_mfma_f32_32x32x16_bf16 v[64:79], v[44:47], v[40:43], v[64:79]
    s_waitcnt vmcnt(6)
    s_barrier
    s_add_u32 m0, s31, 24576
    s_mov_b32 s26, 22020992
    buffer_load_dwordx4 v10, s[12:15], s26 offen lds
    s_add_u32 m0, s32, 24576
    s_mov_b32 s26, 458752
    buffer_load_dwordx4 v12, s[8:11], s26 offen lds
    s_add_u32 m0, s32, 25600
    s_mov_b32 s26, 458752
    buffer_load_dwordx4 v13, s[8:11], s26 offen lds
    ds_read_b128 v[24:27], v14 offset:36864
    ds_read_b128 v[28:31], v14 offset:38912
    ds_read_b64_tr_b16 v[32:33], v16 offset:36864
    ds_read_b64_tr_b16 v[34:35], v16 offset:37888
    ds_read_b128 v[36:39], v15 offset:36864
    ds_read_b128 v[40:43], v15 offset:38912
    ds_read_b64_tr_b16 v[44:45], v16 offset:40960
    ds_read_b64_tr_b16 v[46:47], v16 offset:41984
    s_waitcnt lgkmcnt(4)
    v_mfma_f32_32x32x16_bf16 v[48:63], v[32:35], v[24:27], v[48:63]
    v_mfma_f32_32x32x16_bf16 v[64:79], v[32:35], v[28:31], v[64:79]
    s_waitcnt lgkmcnt(0)
    v_mfma_f32_32x32x16_bf16 v[48:63], v[44:47], v[36:39], v[48:63]
    v_mfma_f32_32x32x16_bf16 v[64:79], v[44:47], v[40:43], v[64:79]
    s_waitcnt vmcnt(6)
    s_barrier
    s_add_u32 m0, s31, 36864
    s_mov_b32 s26, 22021056
    buffer_load_dwordx4 v10, s[12:15], s26 offen lds
    s_add_u32 m0, s32, 36864
    s_mov_b32 s26, 491520
    buffer_load_dwordx4 v12, s[8:11], s26 offen lds
    s_add_u32 m0, s32, 37888
    s_mov_b32 s26, 491520
    buffer_load_dwordx4 v13, s[8:11], s26 offen lds
    ds_read_b128 v[24:27], v14 offset:0
    ds_read_b128 v[28:31], v14 offset:2048
    ds_read_b64_tr_b16 v[32:33], v16 offset:0
    ds_read_b64_tr_b16 v[34:35], v16 offset:1024
    ds_read_b128 v[36:39], v15 offset:0
    ds_read_b128 v[40:43], v15 offset:2048
    ds_read_b64_tr_b16 v[44:45], v16 offset:4096
    ds_read_b64_tr_b16 v[46:47], v16 offset:5120
    s_waitcnt lgkmcnt(4)
    v_mfma_f32_32x32x16_bf16 v[48:63], v[32:35], v[24:27], v[48:63]
    v_mfma_f32_32x32x16_bf16 v[64:79], v[32:35], v[28:31], v[64:79]
    s_waitcnt lgkmcnt(0)
    v_mfma_f32_32x32x16_bf16 v[48:63], v[44:47], v[36:39], v[48:63]
    v_mfma_f32_32x32x16_bf16 v[64:79], v[44:47], v[40:43], v[64:79]
    s_waitcnt vmcnt(6)
    s_barrier
    s_add_u32 m0, s31, 0
    s_mov_b32 s26, 22021120
    buffer_load_dwordx4 v10, s[12:15], s26 offen lds
    s_add_u32 m0, s32, 0
    s_mov_b32 s26, 524288
    buffer_load_dwordx4 v12, s[8:11], s26 offen lds
    s_add_u32 m0, s32, 1024
    s_mov_b32 s26, 524288
    buffer_load_dwordx4 v13, s[8:11], s26 offen lds
    ds_read_b128 v[24:27], v14 offset:12288
    ds_read_b128 v[28:31], v14 offset:14336
    ds_read_b64_tr_b16 v[32:33], v16 offset:12288
    ds_read_b64_tr_b16 v[34:35], v16 offset:13312
    ds_read_b128 v[36:39], v15 offset:12288
    ds_read_b128 v[40:43], v15 offset:14336
    ds_read_b64_tr_b16 v[44:45], v16 offset:16384
    ds_read_b64_tr_b16 v[46:47], v16 offset:17408
    s_waitcnt lgkmcnt(4)
    v_mfma_f32_32x32x16_bf16 v[48:63], v[32:35], v[24:27], v[48:63]
    v_mfma_f32_32x32x16_bf16 v[64:79], v[32:35], v[28:31], v[64:79]
    s_waitcnt lgkmcnt(0)
    v_mfma_f32_32x32x16_bf16 v[48:63], v[44:47], v[36:39], v[48:63]
    v_mfma_f32_32x32x16_bf16 v[64:79], v[44:47], v[40:43], v[64:79]
    s_waitcnt vmcnt(6)
    s_barrier
    s_add_u32 m0, s31, 12288
    s_mov_b32 s26, 22021184
    buffer_load_dwordx4 v10, s[12:15], s26 offen lds
    s_add_u32 m0, s32, 12288
    s_mov_b32 s26, 557056
    buffer_load_dwordx4 v12, s[8:11], s26 offen lds
    s_add_u32 m0, s32, 13312
    s_mov_b32 s26, 557056
    buffer_load_dwordx4 v13, s[8:11], s26 offen lds
    ds_read_b128 v[24:27], v14 offset:24576
    ds_read_b128 v[28:31], v14 offset:26624
    ds_read_b64_tr_b16 v[32:33], v16 offset:24576
    ds_read_b64_tr_b16 v[34:35], v16 offset:25600
    ds_read_b128 v[36:39], v15 offset:24576
    ds_read_b128 v[40:43], v15 offset:26624
    ds_read_b64_tr_b16 v[44:45], v16 offset:28672
    ds_read_b64_tr_b16 v[46:47], v16 offset:29696
    s_waitcnt lgkmcnt(4)
    v_mfma_f32_32x32x16_bf16 v[48:63], v[32:35], v[24:27], v[48:63]
    v_mfma_f32_32x32x16_bf16 v[64:79], v[32:35], v[28:31], v[64:79]
    s_waitcnt lgkmcnt(0)
    v_mfma_f32_32x32x16_bf16 v[48:63], v[44:47], v[36:39], v[48:63]
    v_mfma_f32_32x32x16_bf16 v[64:79], v[44:47], v[40:43], v[64:79]
    s_waitcnt vmcnt(6)
    s_barrier
    s_add_u32 m0, s31, 24576
    s_mov_b32 s26, 22021248
    buffer_load_dwordx4 v10, s[12:15], s26 offen lds
    s_add_u32 m0, s32, 24576
    s_mov_b32 s26, 589824
    buffer_load_dwordx4 v12, s[8:11], s26 offen lds
    s_add_u32 m0, s32, 25600
    s_mov_b32 s26, 589824
    buffer_load_dwordx4 v13, s[8:11], s26 offen lds
    ds_read_b128 v[24:27], v14 offset:36864
    ds_read_b128 v[28:31], v14 offset:38912
    ds_read_b64_tr_b16 v[32:33], v16 offset:36864
    ds_read_b64_tr_b16 v[34:35], v16 offset:37888
    ds_read_b128 v[36:39], v15 offset:36864
    ds_read_b128 v[40:43], v15 offset:38912
    ds_read_b64_tr_b16 v[44:45], v16 offset:40960
    ds_read_b64_tr_b16 v[46:47], v16 offset:41984
    s_waitcnt lgkmcnt(4)
    v_mfma_f32_32x32x16_bf16 v[48:63], v[32:35], v[24:27], v[48:63]
    v_mfma_f32_32x32x16_bf16 v[64:79], v[32:35], v[28:31], v[64:79]
    s_waitcnt lgkmcnt(0)
    v_mfma_f32_32x32x16_bf16 v[48:63], v[44:47], v[36:39], v[48:63]
    v_mfma_f32_32x32x16_bf16 v[64:79], v[44:47], v[40:43], v[64:79]
    s_waitcnt vmcnt(6)
    s_barrier
    s_add_u32 m0, s31, 36864
    s_mov_b32 s26, 22021312
    buffer_load_dwordx4 v10, s[12:15], s26 offen lds
    s_add_u32 m0, s32, 36864
    s_mov_b32 s26, 622592
    buffer_load_dwordx4 v12, s[8:11], s26 offen lds
    s_add_u32 m0, s32, 37888
    s_mov_b32 s26, 622592
    buffer_load_dwordx4 v13, s[8:11], s26 offen lds
    ds_read_b128 v[24:27], v14 offset:0
    ds_read_b128 v[28:31], v14 offset:2048
    ds_read_b64_tr_b16 v[32:33], v16 offset:0
    ds_read_b64_tr_b16 v[34:35], v16 offset:1024
    ds_read_b128 v[36:39], v15 offset:0
    ds_read_b128 v[40:43], v15 offset:2048
    ds_read_b64_tr_b16 v[44:45], v16 offset:4096
    ds_read_b64_tr_b16 v[46:47], v16 offset:5120
    s_waitcnt lgkmcnt(4)
    v_mfma_f32_32x32x16_bf16 v[48:63], v[32:35], v[24:27], v[48:63]
    v_mfma_f32_32x32x16_bf16 v[64:79], v[32:35], v[28:31], v[64:79]
    s_waitcnt lgkmcnt(0)
    v_mfma_f32_32x32x16_bf16 v[48:63], v[44:47], v[36:39], v[48:63]
    v_mfma_f32_32x32x16_bf16 v[64:79], v[44:47], v[40:43], v[64:79]
    s_waitcnt vmcnt(6)
    s_barrier
    s_add_u32 m0, s31, 0
    s_mov_b32 s26, 22021376
    buffer_load_dwordx4 v10, s[12:15], s26 offen lds
    s_add_u32 m0, s32, 0
    s_mov_b32 s26, 655360
    buffer_load_dwordx4 v12, s[8:11], s26 offen lds
    s_add_u32 m0, s32, 1024
    s_mov_b32 s26, 655360
    buffer_load_dwordx4 v13, s[8:11], s26 offen lds
    ds_read_b128 v[24:27], v14 offset:12288
    ds_read_b128 v[28:31], v14 offset:14336
    ds_read_b64_tr_b16 v[32:33], v16 offset:12288
    ds_read_b64_tr_b16 v[34:35], v16 offset:13312
    ds_read_b128 v[36:39], v15 offset:12288
    ds_read_b128 v[40:43], v15 offset:14336
    ds_read_b64_tr_b16 v[44:45], v16 offset:16384
    ds_read_b64_tr_b16 v[46:47], v16 offset:17408
    s_waitcnt lgkmcnt(4)
    v_mfma_f32_32x32x16_bf16 v[48:63], v[32:35], v[24:27], v[48:63]
    v_mfma_f32_32x32x16_bf16 v[64:79], v[32:35], v[28:31], v[64:79]
    s_waitcnt lgkmcnt(0)
    v_mfma_f32_32x32x16_bf16 v[48:63], v[44:47], v[36:39], v[48:63]
    v_mfma_f32_32x32x16_bf16 v[64:79], v[44:47], v[40:43], v[64:79]
    s_waitcnt vmcnt(6)
    s_barrier
    s_add_u32 m0, s31, 12288
    s_mov_b32 s26, 22021440
    buffer_load_dwordx4 v10, s[12:15], s26 offen lds
    s_add_u32 m0, s32, 12288
    s_mov_b32 s26, 688128
    buffer_load_dwordx4 v12, s[8:11], s26 offen lds
    s_add_u32 m0, s32, 13312
    s_mov_b32 s26, 688128
    buffer_load_dwordx4 v13, s[8:11], s26 offen lds
    ds_read_b128 v[24:27], v14 offset:24576
    ds_read_b128 v[28:31], v14 offset:26624
    ds_read_b64_tr_b16 v[32:33], v16 offset:24576
    ds_read_b64_tr_b16 v[34:35], v16 offset:25600
    ds_read_b128 v[36:39], v15 offset:24576
    ds_read_b128 v[40:43], v15 offset:26624
    ds_read_b64_tr_b16 v[44:45], v16 offset:28672
    ds_read_b64_tr_b16 v[46:47], v16 offset:29696
    s_waitcnt lgkmcnt(4)
    v_mfma_f32_32x32x16_bf16 v[48:63], v[32:35], v[24:27], v[48:63]
    v_mfma_f32_32x32x16_bf16 v[64:79], v[32:35], v[28:31], v[64:79]
    s_waitcnt lgkmcnt(0)
    v_mfma_f32_32x32x16_bf16 v[48:63], v[44:47], v[36:39], v[48:63]
    v_mfma_f32_32x32x16_bf16 v[64:79], v[44:47], v[40:43], v[64:79]
    s_waitcnt vmcnt(6)
    s_barrier
    s_add_u32 m0, s31, 24576
    s_mov_b32 s26, 22021504
    buffer_load_dwordx4 v10, s[12:15], s26 offen lds
    s_add_u32 m0, s32, 24576
    s_mov_b32 s26, 720896
    buffer_load_dwordx4 v12, s[8:11], s26 offen lds
    s_add_u32 m0, s32, 25600
    s_mov_b32 s26, 720896
    buffer_load_dwordx4 v13, s[8:11], s26 offen lds
    ds_read_b128 v[24:27], v14 offset:36864
    ds_read_b128 v[28:31], v14 offset:38912
    ds_read_b64_tr_b16 v[32:33], v16 offset:36864
    ds_read_b64_tr_b16 v[34:35], v16 offset:37888
    ds_read_b128 v[36:39], v15 offset:36864
    ds_read_b128 v[40:43], v15 offset:38912
    ds_read_b64_tr_b16 v[44:45], v16 offset:40960
    ds_read_b64_tr_b16 v[46:47], v16 offset:41984
    s_waitcnt lgkmcnt(4)
    v_mfma_f32_32x32x16_bf16 v[48:63], v[32:35], v[24:27], v[48:63]
    v_mfma_f32_32x32x16_bf16 v[64:79], v[32:35], v[28:31], v[64:79]
    s_waitcnt lgkmcnt(0)
    v_mfma_f32_32x32x16_bf16 v[48:63], v[44:47], v[36:39], v[48:63]
    v_mfma_f32_32x32x16_bf16 v[64:79], v[44:47], v[40:43], v[64:79]
    s_waitcnt vmcnt(6)
    s_barrier
    s_add_u32 m0, s31, 36864
    s_mov_b32 s26, 22021568
    buffer_load_dwordx4 v10, s[12:15], s26 offen lds
    s_add_u32 m0, s32, 36864
    s_mov_b32 s26, 753664
    buffer_load_dwordx4 v12, s[8:11], s26 offen lds
    s_add_u32 m0, s32, 37888
    s_mov_b32 s26, 753664
    buffer_load_dwordx4 v13, s[8:11], s26 offen lds
    ds_read_b128 v[24:27], v14 offset:0
    ds_read_b128 v[28:31], v14 offset:2048
    ds_read_b64_tr_b16 v[32:33], v16 offset:0
    ds_read_b64_tr_b16 v[34:35], v16 offset:1024
    ds_read_b128 v[36:39], v15 offset:0
    ds_read_b128 v[40:43], v15 offset:2048
    ds_read_b64_tr_b16 v[44:45], v16 offset:4096
    ds_read_b64_tr_b16 v[46:47], v16 offset:5120
    s_waitcnt lgkmcnt(4)
    v_mfma_f32_32x32x16_bf16 v[48:63], v[32:35], v[24:27], v[48:63]
    v_mfma_f32_32x32x16_bf16 v[64:79], v[32:35], v[28:31], v[64:79]
    s_waitcnt lgkmcnt(0)
    v_mfma_f32_32x32x16_bf16 v[48:63], v[44:47], v[36:39], v[48:63]
    v_mfma_f32_32x32x16_bf16 v[64:79], v[44:47], v[40:43], v[64:79]
    s_waitcnt vmcnt(6)
    s_barrier
    s_add_u32 m0, s31, 0
    s_mov_b32 s26, 22021632
    buffer_load_dwordx4 v10, s[12:15], s26 offen lds
    s_add_u32 m0, s32, 0
    s_mov_b32 s26, 786432
    buffer_load_dwordx4 v12, s[8:11], s26 offen lds
    s_add_u32 m0, s32, 1024
    s_mov_b32 s26, 786432
    buffer_load_dwordx4 v13, s[8:11], s26 offen lds
    ds_read_b128 v[24:27], v14 offset:12288
    ds_read_b128 v[28:31], v14 offset:14336
    ds_read_b64_tr_b16 v[32:33], v16 offset:12288
    ds_read_b64_tr_b16 v[34:35], v16 offset:13312
    ds_read_b128 v[36:39], v15 offset:12288
    ds_read_b128 v[40:43], v15 offset:14336
    ds_read_b64_tr_b16 v[44:45], v16 offset:16384
    ds_read_b64_tr_b16 v[46:47], v16 offset:17408
    s_waitcnt lgkmcnt(4)
    v_mfma_f32_32x32x16_bf16 v[48:63], v[32:35], v[24:27], v[48:63]
    v_mfma_f32_32x32x16_bf16 v[64:79], v[32:35], v[28:31], v[64:79]
    s_waitcnt lgkmcnt(0)
    v_mfma_f32_32x32x16_bf16 v[48:63], v[44:47], v[36:39], v[48:63]
    v_mfma_f32_32x32x16_bf16 v[64:79], v[44:47], v[40:43], v[64:79]
    s_waitcnt vmcnt(6)
    s_barrier
    s_add_u32 m0, s31, 12288
    s_mov_b32 s26, 22021696
    buffer_load_dwordx4 v10, s[12:15], s26 offen lds
    s_add_u32 m0, s32, 12288
    s_mov_b32 s26, 819200
    buffer_load_dwordx4 v12, s[8:11], s26 offen lds
    s_add_u32 m0, s32, 13312
    s_mov_b32 s26, 819200
    buffer_load_dwordx4 v13, s[8:11], s26 offen lds
    ds_read_b128 v[24:27], v14 offset:24576
    ds_read_b128 v[28:31], v14 offset:26624
    ds_read_b64_tr_b16 v[32:33], v16 offset:24576
    ds_read_b64_tr_b16 v[34:35], v16 offset:25600
    ds_read_b128 v[36:39], v15 offset:24576
    ds_read_b128 v[40:43], v15 offset:26624
    ds_read_b64_tr_b16 v[44:45], v16 offset:28672
    ds_read_b64_tr_b16 v[46:47], v16 offset:29696
    s_waitcnt lgkmcnt(4)
    v_mfma_f32_32x32x16_bf16 v[48:63], v[32:35], v[24:27], v[48:63]
    v_mfma_f32_32x32x16_bf16 v[64:79], v[32:35], v[28:31], v[64:79]
    s_waitcnt lgkmcnt(0)
    v_mfma_f32_32x32x16_bf16 v[48:63], v[44:47], v[36:39], v[48:63]
    v_mfma_f32_32x32x16_bf16 v[64:79], v[44:47], v[40:43], v[64:79]
    s_waitcnt vmcnt(6)
    s_barrier
    s_add_u32 m0, s31, 24576
    s_mov_b32 s26, 22021760
    buffer_load_dwordx4 v10, s[12:15], s26 offen lds
    s_add_u32 m0, s32, 24576
    s_mov_b32 s26, 851968
    buffer_load_dwordx4 v12, s[8:11], s26 offen lds
    s_add_u32 m0, s32, 25600
    s_mov_b32 s26, 851968
    buffer_load_dwordx4 v13, s[8:11], s26 offen lds
    ds_read_b128 v[24:27], v14 offset:36864
    ds_read_b128 v[28:31], v14 offset:38912
    ds_read_b64_tr_b16 v[32:33], v16 offset:36864
    ds_read_b64_tr_b16 v[34:35], v16 offset:37888
    ds_read_b128 v[36:39], v15 offset:36864
    ds_read_b128 v[40:43], v15 offset:38912
    ds_read_b64_tr_b16 v[44:45], v16 offset:40960
    ds_read_b64_tr_b16 v[46:47], v16 offset:41984
    s_waitcnt lgkmcnt(4)
    v_mfma_f32_32x32x16_bf16 v[48:63], v[32:35], v[24:27], v[48:63]
    v_mfma_f32_32x32x16_bf16 v[64:79], v[32:35], v[28:31], v[64:79]
    s_waitcnt lgkmcnt(0)
    v_mfma_f32_32x32x16_bf16 v[48:63], v[44:47], v[36:39], v[48:63]
    v_mfma_f32_32x32x16_bf16 v[64:79], v[44:47], v[40:43], v[64:79]
    s_waitcnt vmcnt(6)
    s_barrier
    s_add_u32 m0, s31, 36864
    s_mov_b32 s26, 22021824
    buffer_load_dwordx4 v10, s[12:15], s26 offen lds
    s_add_u32 m0, s32, 36864
    s_mov_b32 s26, 884736
    buffer_load_dwordx4 v12, s[8:11], s26 offen lds
    s_add_u32 m0, s32, 37888
    s_mov_b32 s26, 884736
    buffer_load_dwordx4 v13, s[8:11], s26 offen lds
    ds_read_b128 v[24:27], v14 offset:0
    ds_read_b128 v[28:31], v14 offset:2048
    ds_read_b64_tr_b16 v[32:33], v16 offset:0
    ds_read_b64_tr_b16 v[34:35], v16 offset:1024
    ds_read_b128 v[36:39], v15 offset:0
    ds_read_b128 v[40:43], v15 offset:2048
    ds_read_b64_tr_b16 v[44:45], v16 offset:4096
    ds_read_b64_tr_b16 v[46:47], v16 offset:5120
    s_waitcnt lgkmcnt(4)
    v_mfma_f32_32x32x16_bf16 v[48:63], v[32:35], v[24:27], v[48:63]
    v_mfma_f32_32x32x16_bf16 v[64:79], v[32:35], v[28:31], v[64:79]
    s_waitcnt lgkmcnt(0)
    v_mfma_f32_32x32x16_bf16 v[48:63], v[44:47], v[36:39], v[48:63]
    v_mfma_f32_32x32x16_bf16 v[64:79], v[44:47], v[40:43], v[64:79]
    s_waitcnt vmcnt(6)
    s_barrier
    s_add_u32 m0, s31, 0
    s_mov_b32 s26, 22021888
    buffer_load_dwordx4 v10, s[12:15], s26 offen lds
    s_add_u32 m0, s32, 0
    s_mov_b32 s26, 917504
    buffer_load_dwordx4 v12, s[8:11], s26 offen lds
    s_add_u32 m0, s32, 1024
    s_mov_b32 s26, 917504
    buffer_load_dwordx4 v13, s[8:11], s26 offen lds
    ds_read_b128 v[24:27], v14 offset:12288
    ds_read_b128 v[28:31], v14 offset:14336
    ds_read_b64_tr_b16 v[32:33], v16 offset:12288
    ds_read_b64_tr_b16 v[34:35], v16 offset:13312
    ds_read_b128 v[36:39], v15 offset:12288
    ds_read_b128 v[40:43], v15 offset:14336
    ds_read_b64_tr_b16 v[44:45], v16 offset:16384
    ds_read_b64_tr_b16 v[46:47], v16 offset:17408
    s_waitcnt lgkmcnt(4)
    v_mfma_f32_32x32x16_bf16 v[48:63], v[32:35], v[24:27], v[48:63]
    v_mfma_f32_32x32x16_bf16 v[64:79], v[32:35], v[28:31], v[64:79]
    s_waitcnt lgkmcnt(0)
    v_mfma_f32_32x32x16_bf16 v[48:63], v[44:47], v[36:39], v[48:63]
    v_mfma_f32_32x32x16_bf16 v[64:79], v[44:47], v[40:43], v[64:79]
    s_waitcnt vmcnt(6)
    s_barrier
    s_add_u32 m0, s31, 12288
    s_mov_b32 s26, 22021952
    buffer_load_dwordx4 v10, s[12:15], s26 offen lds
    s_add_u32 m0, s32, 12288
    s_mov_b32 s26, 950272
    buffer_load_dwordx4 v12, s[8:11], s26 offen lds
    s_add_u32 m0, s32, 13312
    s_mov_b32 s26, 950272
    buffer_load_dwordx4 v13, s[8:11], s26 offen lds
    ds_read_b128 v[24:27], v14 offset:24576
    ds_read_b128 v[28:31], v14 offset:26624
    ds_read_b64_tr_b16 v[32:33], v16 offset:24576
    ds_read_b64_tr_b16 v[34:35], v16 offset:25600
    ds_read_b128 v[36:39], v15 offset:24576
    ds_read_b128 v[40:43], v15 offset:26624
    ds_read_b64_tr_b16 v[44:45], v16 offset:28672
    ds_read_b64_tr_b16 v[46:47], v16 offset:29696
    s_waitcnt lgkmcnt(4)
    v_mfma_f32_32x32x16_bf16 v[48:63], v[32:35], v[24:27], v[48:63]
    v_mfma_f32_32x32x16_bf16 v[64:79], v[32:35], v[28:31], v[64:79]
    s_waitcnt lgkmcnt(0)
    v_mfma_f32_32x32x16_bf16 v[48:63], v[44:47], v[36:39], v[48:63]
    v_mfma_f32_32x32x16_bf16 v[64:79], v[44:47], v[40:43], v[64:79]
    s_waitcnt vmcnt(6)
    s_barrier
    s_add_u32 m0, s31, 24576
    s_mov_b32 s26, 22022016
    buffer_load_dwordx4 v10, s[12:15], s26 offen lds
    s_add_u32 m0, s32, 24576
    s_mov_b32 s26, 983040
    buffer_load_dwordx4 v12, s[8:11], s26 offen lds
    s_add_u32 m0, s32, 25600
    s_mov_b32 s26, 983040
    buffer_load_dwordx4 v13, s[8:11], s26 offen lds
    ds_read_b128 v[24:27], v14 offset:36864
    ds_read_b128 v[28:31], v14 offset:38912
    ds_read_b64_tr_b16 v[32:33], v16 offset:36864
    ds_read_b64_tr_b16 v[34:35], v16 offset:37888
    ds_read_b128 v[36:39], v15 offset:36864
    ds_read_b128 v[40:43], v15 offset:38912
    ds_read_b64_tr_b16 v[44:45], v16 offset:40960
    ds_read_b64_tr_b16 v[46:47], v16 offset:41984
    s_waitcnt lgkmcnt(4)
    v_mfma_f32_32x32x16_bf16 v[48:63], v[32:35], v[24:27], v[48:63]
    v_mfma_f32_32x32x16_bf16 v[64:79], v[32:35], v[28:31], v[64:79]
    s_waitcnt lgkmcnt(0)
    v_mfma_f32_32x32x16_bf16 v[48:63], v[44:47], v[36:39], v[48:63]
    v_mfma_f32_32x32x16_bf16 v[64:79], v[44:47], v[40:43], v[64:79]
    s_waitcnt vmcnt(6)
    s_barrier
    s_add_u32 m0, s31, 36864
    s_mov_b32 s26, 22022080
    buffer_load_dwordx4 v10, s[12:15], s26 offen lds
    s_add_u32 m0, s32, 36864
    s_mov_b32 s26, 1015808
    buffer_load_dwordx4 v12, s[8:11], s26 offen lds
    s_add_u32 m0, s32, 37888
    s_mov_b32 s26, 1015808
    buffer_load_dwordx4 v13, s[8:11], s26 offen lds
    ds_read_b128 v[24:27], v14 offset:0
    ds_read_b128 v[28:31], v14 offset:2048
    ds_read_b64_tr_b16 v[32:33], v16 offset:0
    ds_read_b64_tr_b16 v[34:35], v16 offset:1024
    ds_read_b128 v[36:39], v15 offset:0
    ds_read_b128 v[40:43], v15 offset:2048
    ds_read_b64_tr_b16 v[44:45], v16 offset:4096
    ds_read_b64_tr_b16 v[46:47], v16 offset:5120
    s_waitcnt lgkmcnt(4)
    v_mfma_f32_32x32x16_bf16 v[48:63], v[32:35], v[24:27], v[48:63]
    v_mfma_f32_32x32x16_bf16 v[64:79], v[32:35], v[28:31], v[64:79]
    s_waitcnt lgkmcnt(0)
    v_mfma_f32_32x32x16_bf16 v[48:63], v[44:47], v[36:39], v[48:63]
    v_mfma_f32_32x32x16_bf16 v[64:79], v[44:47], v[40:43], v[64:79]
    s_waitcnt vmcnt(6)
    s_barrier
    s_add_u32 m0, s31, 0
    s_mov_b32 s26, 22022144
    buffer_load_dwordx4 v10, s[12:15], s26 offen lds
    s_add_u32 m0, s32, 0
    s_mov_b32 s26, 1048576
    buffer_load_dwordx4 v12, s[8:11], s26 offen lds
    s_add_u32 m0, s32, 1024
    s_mov_b32 s26, 1048576
    buffer_load_dwordx4 v13, s[8:11], s26 offen lds
    ds_read_b128 v[24:27], v14 offset:12288
    ds_read_b128 v[28:31], v14 offset:14336
    ds_read_b64_tr_b16 v[32:33], v16 offset:12288
    ds_read_b64_tr_b16 v[34:35], v16 offset:13312
    ds_read_b128 v[36:39], v15 offset:12288
    ds_read_b128 v[40:43], v15 offset:14336
    ds_read_b64_tr_b16 v[44:45], v16 offset:16384
    ds_read_b64_tr_b16 v[46:47], v16 offset:17408
    s_waitcnt lgkmcnt(4)
    v_mfma_f32_32x32x16_bf16 v[48:63], v[32:35], v[24:27], v[48:63]
    v_mfma_f32_32x32x16_bf16 v[64:79], v[32:35], v[28:31], v[64:79]
    s_waitcnt lgkmcnt(0)
    v_mfma_f32_32x32x16_bf16 v[48:63], v[44:47], v[36:39], v[48:63]
    v_mfma_f32_32x32x16_bf16 v[64:79], v[44:47], v[40:43], v[64:79]
    s_waitcnt vmcnt(6)
    s_barrier
    s_add_u32 m0, s31, 12288
    s_mov_b32 s26, 22022208
    buffer_load_dwordx4 v10, s[12:15], s26 offen lds
    s_add_u32 m0, s32, 12288
    s_mov_b32 s26, 1081344
    buffer_load_dwordx4 v12, s[8:11], s26 offen lds
    s_add_u32 m0, s32, 13312
    s_mov_b32 s26, 1081344
    buffer_load_dwordx4 v13, s[8:11], s26 offen lds
    ds_read_b128 v[24:27], v14 offset:24576
    ds_read_b128 v[28:31], v14 offset:26624
    ds_read_b64_tr_b16 v[32:33], v16 offset:24576
    ds_read_b64_tr_b16 v[34:35], v16 offset:25600
    ds_read_b128 v[36:39], v15 offset:24576
    ds_read_b128 v[40:43], v15 offset:26624
    ds_read_b64_tr_b16 v[44:45], v16 offset:28672
    ds_read_b64_tr_b16 v[46:47], v16 offset:29696
    s_waitcnt lgkmcnt(4)
    v_mfma_f32_32x32x16_bf16 v[48:63], v[32:35], v[24:27], v[48:63]
    v_mfma_f32_32x32x16_bf16 v[64:79], v[32:35], v[28:31], v[64:79]
    s_waitcnt lgkmcnt(0)
    v_mfma_f32_32x32x16_bf16 v[48:63], v[44:47], v[36:39], v[48:63]
    v_mfma_f32_32x32x16_bf16 v[64:79], v[44:47], v[40:43], v[64:79]
    s_waitcnt vmcnt(6)
    s_barrier
    s_add_u32 m0, s31, 24576
    s_mov_b32 s26, 22022272
    buffer_load_dwordx4 v10, s[12:15], s26 offen lds
    s_add_u32 m0, s32, 24576
    s_mov_b32 s26, 1114112
    buffer_load_dwordx4 v12, s[8:11], s26 offen lds
    s_add_u32 m0, s32, 25600
    s_mov_b32 s26, 1114112
    buffer_load_dwordx4 v13, s[8:11], s26 offen lds
    ds_read_b128 v[24:27], v14 offset:36864
    ds_read_b128 v[28:31], v14 offset:38912
    ds_read_b64_tr_b16 v[32:33], v16 offset:36864
    ds_read_b64_tr_b16 v[34:35], v16 offset:37888
    ds_read_b128 v[36:39], v15 offset:36864
    ds_read_b128 v[40:43], v15 offset:38912
    ds_read_b64_tr_b16 v[44:45], v16 offset:40960
    ds_read_b64_tr_b16 v[46:47], v16 offset:41984
    s_waitcnt lgkmcnt(4)
    v_mfma_f32_32x32x16_bf16 v[48:63], v[32:35], v[24:27], v[48:63]
    v_mfma_f32_32x32x16_bf16 v[64:79], v[32:35], v[28:31], v[64:79]
    s_waitcnt lgkmcnt(0)
    v_mfma_f32_32x32x16_bf16 v[48:63], v[44:47], v[36:39], v[48:63]
    v_mfma_f32_32x32x16_bf16 v[64:79], v[44:47], v[40:43], v[64:79]
    s_waitcnt vmcnt(6)
    s_barrier
    s_add_u32 m0, s31, 36864
    s_mov_b32 s26, 22022336
    buffer_load_dwordx4 v10, s[12:15], s26 offen lds
    s_add_u32 m0, s32, 36864
    s_mov_b32 s26, 1146880
    buffer_load_dwordx4 v12, s[8:11], s26 offen lds
    s_add_u32 m0, s32, 37888
    s_mov_b32 s26, 1146880
    buffer_load_dwordx4 v13, s[8:11], s26 offen lds
    ds_read_b128 v[24:27], v14 offset:0
    ds_read_b128 v[28:31], v14 offset:2048
    ds_read_b64_tr_b16 v[32:33], v16 offset:0
    ds_read_b64_tr_b16 v[34:35], v16 offset:1024
    ds_read_b128 v[36:39], v15 offset:0
    ds_read_b128 v[40:43], v15 offset:2048
    ds_read_b64_tr_b16 v[44:45], v16 offset:4096
    ds_read_b64_tr_b16 v[46:47], v16 offset:5120
    s_waitcnt lgkmcnt(4)
    v_mfma_f32_32x32x16_bf16 v[48:63], v[32:35], v[24:27], v[48:63]
    v_mfma_f32_32x32x16_bf16 v[64:79], v[32:35], v[28:31], v[64:79]
    s_waitcnt lgkmcnt(0)
    v_mfma_f32_32x32x16_bf16 v[48:63], v[44:47], v[36:39], v[48:63]
    v_mfma_f32_32x32x16_bf16 v[64:79], v[44:47], v[40:43], v[64:79]
    s_waitcnt vmcnt(6)
    s_barrier
    s_add_u32 m0, s31, 0
    s_mov_b32 s26, 22022400
    buffer_load_dwordx4 v10, s[12:15], s26 offen lds
    s_add_u32 m0, s32, 0
    s_mov_b32 s26, 1179648
    buffer_load_dwordx4 v12, s[8:11], s26 offen lds
    s_add_u32 m0, s32, 1024
    s_mov_b32 s26, 1179648
    buffer_load_dwordx4 v13, s[8:11], s26 offen lds
    ds_read_b128 v[24:27], v14 offset:12288
    ds_read_b128 v[28:31], v14 offset:14336
    ds_read_b64_tr_b16 v[32:33], v16 offset:12288
    ds_read_b64_tr_b16 v[34:35], v16 offset:13312
    ds_read_b128 v[36:39], v15 offset:12288
    ds_read_b128 v[40:43], v15 offset:14336
    ds_read_b64_tr_b16 v[44:45], v16 offset:16384
    ds_read_b64_tr_b16 v[46:47], v16 offset:17408
    s_waitcnt lgkmcnt(4)
    v_mfma_f32_32x32x16_bf16 v[48:63], v[32:35], v[24:27], v[48:63]
    v_mfma_f32_32x32x16_bf16 v[64:79], v[32:35], v[28:31], v[64:79]
    s_waitcnt lgkmcnt(0)
    v_mfma_f32_32x32x16_bf16 v[48:63], v[44:47], v[36:39], v[48:63]
    v_mfma_f32_32x32x16_bf16 v[64:79], v[44:47], v[40:43], v[64:79]
    s_waitcnt vmcnt(6)
    s_barrier
    s_add_u32 m0, s31, 12288
    s_mov_b32 s26, 22022464
    buffer_load_dwordx4 v10, s[12:15], s26 offen lds
    s_add_u32 m0, s32, 12288
    s_mov_b32 s26, 1212416
    buffer_load_dwordx4 v12, s[8:11], s26 offen lds
    s_add_u32 m0, s32, 13312
    s_mov_b32 s26, 1212416
    buffer_load_dwordx4 v13, s[8:11], s26 offen lds
    ds_read_b128 v[24:27], v14 offset:24576
    ds_read_b128 v[28:31], v14 offset:26624
    ds_read_b64_tr_b16 v[32:33], v16 offset:24576
    ds_read_b64_tr_b16 v[34:35], v16 offset:25600
    ds_read_b128 v[36:39], v15 offset:24576
    ds_read_b128 v[40:43], v15 offset:26624
    ds_read_b64_tr_b16 v[44:45], v16 offset:28672
    ds_read_b64_tr_b16 v[46:47], v16 offset:29696
    s_waitcnt lgkmcnt(4)
    v_mfma_f32_32x32x16_bf16 v[48:63], v[32:35], v[24:27], v[48:63]
    v_mfma_f32_32x32x16_bf16 v[64:79], v[32:35], v[28:31], v[64:79]
    s_waitcnt lgkmcnt(0)
    v_mfma_f32_32x32x16_bf16 v[48:63], v[44:47], v[36:39], v[48:63]
    v_mfma_f32_32x32x16_bf16 v[64:79], v[44:47], v[40:43], v[64:79]
    s_waitcnt vmcnt(6)
    s_barrier
    s_add_u32 m0, s31, 24576
    s_mov_b32 s26, 22022528
    buffer_load_dwordx4 v10, s[12:15], s26 offen lds
    s_add_u32 m0, s32, 24576
    s_mov_b32 s26, 1245184
    buffer_load_dwordx4 v12, s[8:11], s26 offen lds
    s_add_u32 m0, s32, 25600
    s_mov_b32 s26, 1245184
    buffer_load_dwordx4 v13, s[8:11], s26 offen lds
    ds_read_b128 v[24:27], v14 offset:36864
    ds_read_b128 v[28:31], v14 offset:38912
    ds_read_b64_tr_b16 v[32:33], v16 offset:36864
    ds_read_b64_tr_b16 v[34:35], v16 offset:37888
    ds_read_b128 v[36:39], v15 offset:36864
    ds_read_b128 v[40:43], v15 offset:38912
    ds_read_b64_tr_b16 v[44:45], v16 offset:40960
    ds_read_b64_tr_b16 v[46:47], v16 offset:41984
    s_waitcnt lgkmcnt(4)
    v_mfma_f32_32x32x16_bf16 v[48:63], v[32:35], v[24:27], v[48:63]
    v_mfma_f32_32x32x16_bf16 v[64:79], v[32:35], v[28:31], v[64:79]
    s_waitcnt lgkmcnt(0)
    v_mfma_f32_32x32x16_bf16 v[48:63], v[44:47], v[36:39], v[48:63]
    v_mfma_f32_32x32x16_bf16 v[64:79], v[44:47], v[40:43], v[64:79]
    s_waitcnt vmcnt(6)
    s_barrier
    s_add_u32 m0, s31, 36864
    s_mov_b32 s26, 22022592
    buffer_load_dwordx4 v10, s[12:15], s26 offen lds
    s_add_u32 m0, s32, 36864
    s_mov_b32 s26, 1277952
    buffer_load_dwordx4 v12, s[8:11], s26 offen lds
    s_add_u32 m0, s32, 37888
    s_mov_b32 s26, 1277952
    buffer_load_dwordx4 v13, s[8:11], s26 offen lds
    ds_read_b128 v[24:27], v14 offset:0
    ds_read_b128 v[28:31], v14 offset:2048
    ds_read_b64_tr_b16 v[32:33], v16 offset:0
    ds_read_b64_tr_b16 v[34:35], v16 offset:1024
    ds_read_b128 v[36:39], v15 offset:0
    ds_read_b128 v[40:43], v15 offset:2048
    ds_read_b64_tr_b16 v[44:45], v16 offset:4096
    ds_read_b64_tr_b16 v[46:47], v16 offset:5120
    s_waitcnt lgkmcnt(4)
    v_mfma_f32_32x32x16_bf16 v[48:63], v[32:35], v[24:27], v[48:63]
    v_mfma_f32_32x32x16_bf16 v[64:79], v[32:35], v[28:31], v[64:79]
    s_waitcnt lgkmcnt(0)
    v_mfma_f32_32x32x16_bf16 v[48:63], v[44:47], v[36:39], v[48:63]
    v_mfma_f32_32x32x16_bf16 v[64:79], v[44:47], v[40:43], v[64:79]
    s_waitcnt vmcnt(6)
    s_barrier
    s_add_u32 m0, s31, 0
    s_mov_b32 s26, 22022656
    buffer_load_dwordx4 v10, s[12:15], s26 offen lds
    s_add_u32 m0, s32, 0
    s_mov_b32 s26, 1310720
    buffer_load_dwordx4 v12, s[8:11], s26 offen lds
    s_add_u32 m0, s32, 1024
    s_mov_b32 s26, 1310720
    buffer_load_dwordx4 v13, s[8:11], s26 offen lds
    ds_read_b128 v[24:27], v14 offset:12288
    ds_read_b128 v[28:31], v14 offset:14336
    ds_read_b64_tr_b16 v[32:33], v16 offset:12288
    ds_read_b64_tr_b16 v[34:35], v16 offset:13312
    ds_read_b128 v[36:39], v15 offset:12288
    ds_read_b128 v[40:43], v15 offset:14336
    ds_read_b64_tr_b16 v[44:45], v16 offset:16384
    ds_read_b64_tr_b16 v[46:47], v16 offset:17408
    s_waitcnt lgkmcnt(4)
    v_mfma_f32_32x32x16_bf16 v[48:63], v[32:35], v[24:27], v[48:63]
    v_mfma_f32_32x32x16_bf16 v[64:79], v[32:35], v[28:31], v[64:79]
    s_waitcnt lgkmcnt(0)
    v_mfma_f32_32x32x16_bf16 v[48:63], v[44:47], v[36:39], v[48:63]
    v_mfma_f32_32x32x16_bf16 v[64:79], v[44:47], v[40:43], v[64:79]
    s_waitcnt vmcnt(6)
    s_barrier
    s_add_u32 m0, s31, 12288
    s_mov_b32 s26, 22022720
    buffer_load_dwordx4 v10, s[12:15], s26 offen lds
    s_add_u32 m0, s32, 12288
    s_mov_b32 s26, 1343488
    buffer_load_dwordx4 v12, s[8:11], s26 offen lds
    s_add_u32 m0, s32, 13312
    s_mov_b32 s26, 1343488
    buffer_load_dwordx4 v13, s[8:11], s26 offen lds
    ds_read_b128 v[24:27], v14 offset:24576
    ds_read_b128 v[28:31], v14 offset:26624
    ds_read_b64_tr_b16 v[32:33], v16 offset:24576
    ds_read_b64_tr_b16 v[34:35], v16 offset:25600
    ds_read_b128 v[36:39], v15 offset:24576
    ds_read_b128 v[40:43], v15 offset:26624
    ds_read_b64_tr_b16 v[44:45], v16 offset:28672
    ds_read_b64_tr_b16 v[46:47], v16 offset:29696
    s_waitcnt lgkmcnt(4)
    v_mfma_f32_32x32x16_bf16 v[48:63], v[32:35], v[24:27], v[48:63]
    v_mfma_f32_32x32x16_bf16 v[64:79], v[32:35], v[28:31], v[64:79]
    s_waitcnt lgkmcnt(0)
    v_mfma_f32_32x32x16_bf16 v[48:63], v[44:47], v[36:39], v[48:63]
    v_mfma_f32_32x32x16_bf16 v[64:79], v[44:47], v[40:43], v[64:79]
    s_waitcnt vmcnt(6)
    s_barrier
    s_add_u32 m0, s31, 24576
    s_mov_b32 s26, 22022784
    buffer_load_dwordx4 v10, s[12:15], s26 offen lds
    s_add_u32 m0, s32, 24576
    s_mov_b32 s26, 1376256
    buffer_load_dwordx4 v12, s[8:11], s26 offen lds
    s_add_u32 m0, s32, 25600
    s_mov_b32 s26, 1376256
    buffer_load_dwordx4 v13, s[8:11], s26 offen lds
    ds_read_b128 v[24:27], v14 offset:36864
    ds_read_b128 v[28:31], v14 offset:38912
    ds_read_b64_tr_b16 v[32:33], v16 offset:36864
    ds_read_b64_tr_b16 v[34:35], v16 offset:37888
    ds_read_b128 v[36:39], v15 offset:36864
    ds_read_b128 v[40:43], v15 offset:38912
    ds_read_b64_tr_b16 v[44:45], v16 offset:40960
    ds_read_b64_tr_b16 v[46:47], v16 offset:41984
    s_waitcnt lgkmcnt(4)
    v_mfma_f32_32x32x16_bf16 v[48:63], v[32:35], v[24:27], v[48:63]
    v_mfma_f32_32x32x16_bf16 v[64:79], v[32:35], v[28:31], v[64:79]
    s_waitcnt lgkmcnt(0)
    v_mfma_f32_32x32x16_bf16 v[48:63], v[44:47], v[36:39], v[48:63]
    v_mfma_f32_32x32x16_bf16 v[64:79], v[44:47], v[40:43], v[64:79]
    s_waitcnt vmcnt(6)
    s_barrier
    ds_read_b128 v[24:27], v14 offset:0
    ds_read_b128 v[28:31], v14 offset:2048
    ds_read_b64_tr_b16 v[32:33], v16 offset:0
    ds_read_b64_tr_b16 v[34:35], v16 offset:1024
    ds_read_b128 v[36:39], v15 offset:0
    ds_read_b128 v[40:43], v15 offset:2048
    ds_read_b64_tr_b16 v[44:45], v16 offset:4096
    ds_read_b64_tr_b16 v[46:47], v16 offset:5120
    s_waitcnt lgkmcnt(4)
    v_mfma_f32_32x32x16_bf16 v[48:63], v[32:35], v[24:27], v[48:63]
    v_mfma_f32_32x32x16_bf16 v[64:79], v[32:35], v[28:31], v[64:79]
    s_waitcnt lgkmcnt(0)
    v_mfma_f32_32x32x16_bf16 v[48:63], v[44:47], v[36:39], v[48:63]
    v_mfma_f32_32x32x16_bf16 v[64:79], v[44:47], v[40:43], v[64:79]
    s_waitcnt vmcnt(3)
    s_barrier
    ds_read_b128 v[24:27], v14 offset:12288
    ds_read_b128 v[28:31], v14 offset:14336
    ds_read_b64_tr_b16 v[32:33], v16 offset:12288
    ds_read_b64_tr_b16 v[34:35], v16 offset:13312
    ds_read_b128 v[36:39], v15 offset:12288
    ds_read_b128 v[40:43], v15 offset:14336
    ds_read_b64_tr_b16 v[44:45], v16 offset:16384
    ds_read_b64_tr_b16 v[46:47], v16 offset:17408
    s_waitcnt lgkmcnt(4)
    v_mfma_f32_32x32x16_bf16 v[48:63], v[32:35], v[24:27], v[48:63]
    v_mfma_f32_32x32x16_bf16 v[64:79], v[32:35], v[28:31], v[64:79]
    s_waitcnt lgkmcnt(0)
    v_mfma_f32_32x32x16_bf16 v[48:63], v[44:47], v[36:39], v[48:63]
    v_mfma_f32_32x32x16_bf16 v[64:79], v[44:47], v[40:43], v[64:79]
    s_waitcnt vmcnt(0)
    s_barrier
    ds_read_b128 v[24:27], v14 offset:24576
    ds_read_b128 v[28:31], v14 offset:26624
    ds_read_b64_tr_b16 v[32:33], v16 offset:24576
    ds_read_b64_tr_b16 v[34:35], v16 offset:25600
    ds_read_b128 v[36:39], v15 offset:24576
    ds_read_b128 v[40:43], v15 offset:26624
    ds_read_b64_tr_b16 v[44:45], v16 offset:28672
    ds_read_b64_tr_b16 v[46:47], v16 offset:29696
    s_waitcnt lgkmcnt(4)
    v_mfma_f32_32x32x16_bf16 v[48:63], v[32:35], v[24:27], v[48:63]
    v_mfma_f32_32x32x16_bf16 v[64:79], v[32:35], v[28:31], v[64:79]
    s_waitcnt lgkmcnt(0)
    v_mfma_f32_32x32x16_bf16 v[48:63], v[44:47], v[36:39], v[48:63]
    v_mfma_f32_32x32x16_bf16 v[64:79], v[44:47], v[40:43], v[64:79]
    v_mul_u32_u24 v7, 64, v3
    v_add_u32 v7, v7, v5
    s_mul_i32 s22, s20, 64
    v_add_u32 v7, s22, v7
    s_mov_b32 s24, 1024
    v_mul_lo_u32 v7, v7, s24
    v_mul_u32_u24 v8, 32, v4
    v_lshl_add_u32 v8, v6, 2, v8
    s_mul_i32 s23, s21, 128
    v_add_u32 v8, s23, v8
    v_lshl_add_u32 v7, v8, 1, v7
    s_mov_b32 s27, 0xbfb8aa3b
    v_cvt_pk_bf16_f32 v24, v48, v49
    v_lshlrev_b32 v28, 16, v24
    v_and_b32 v29, 0xffff0000, v24
    v_cvt_pk_bf16_f32 v25, v50, v51
    v_lshlrev_b32 v30, 16, v25
    v_and_b32 v31, 0xffff0000, v25
    v_mul_f32 v32, s27, v28
    v_exp_f32 v32, v32
    v_mul_f32 v33, s27, v29
    v_exp_f32 v33, v33
    v_mul_f32 v34, s27, v30
    v_exp_f32 v34, v34
    v_mul_f32 v35, s27, v31
    v_exp_f32 v35, v35
    v_add_f32 v32, 1.0, v32
    v_rcp_f32 v32, v32
    v_add_f32 v33, 1.0, v33
    v_rcp_f32 v33, v33
    v_add_f32 v34, 1.0, v34
    v_rcp_f32 v34, v34
    v_add_f32 v35, 1.0, v35
    v_rcp_f32 v35, v35
    v_mul_f32 v28, v28, v32
    v_mul_f32 v29, v29, v33
    v_mul_f32 v30, v30, v34
    v_mul_f32 v31, v31, v35
    v_cvt_pk_bf16_f32 v36, v28, v29
    v_cvt_pk_bf16_f32 v37, v30, v31
    s_mov_b32 s26, 29360128
    buffer_store_dwordx2 v[36:37], v7, s[12:15], s26 offen
    v_cvt_pk_bf16_f32 v24, v52, v53
    v_lshlrev_b32 v28, 16, v24
    v_and_b32 v29, 0xffff0000, v24
    v_cvt_pk_bf16_f32 v25, v54, v55
    v_lshlrev_b32 v30, 16, v25
    v_and_b32 v31, 0xffff0000, v25
    v_mul_f32 v32, s27, v28
    v_exp_f32 v32, v32
    v_mul_f32 v33, s27, v29
    v_exp_f32 v33, v33
    v_mul_f32 v34, s27, v30
    v_exp_f32 v34, v34
    v_mul_f32 v35, s27, v31
    v_exp_f32 v35, v35
    v_add_f32 v32, 1.0, v32
    v_rcp_f32 v32, v32
    v_add_f32 v33, 1.0, v33
    v_rcp_f32 v33, v33
    v_add_f32 v34, 1.0, v34
    v_rcp_f32 v34, v34
    v_add_f32 v35, 1.0, v35
    v_rcp_f32 v35, v35
    v_mul_f32 v28, v28, v32
    v_mul_f32 v29, v29, v33
    v_mul_f32 v30, v30, v34
    v_mul_f32 v31, v31, v35
    v_cvt_pk_bf16_f32 v38, v28, v29
    v_cvt_pk_bf16_f32 v39, v30, v31
    s_mov_b32 s26, 29360144
    buffer_store_dwordx2 v[38:39], v7, s[12:15], s26 offen
    v_cvt_pk_bf16_f32 v24, v56, v57
    v_lshlrev_b32 v28, 16, v24
    v_and_b32 v29, 0xffff0000, v24
    v_cvt_pk_bf16_f32 v25, v58, v59
    v_lshlrev_b32 v30, 16, v25
    v_and_b32 v31, 0xffff0000, v25
    v_mul_f32 v32, s27, v28
    v_exp_f32 v32, v32
    v_mul_f32 v33, s27, v29
    v_exp_f32 v33, v33
    v_mul_f32 v34, s27, v30
    v_exp_f32 v34, v34
    v_mul_f32 v35, s27, v31
    v_exp_f32 v35, v35
    v_add_f32 v32, 1.0, v32
    v_rcp_f32 v32, v32
    v_add_f32 v33, 1.0, v33
    v_rcp_f32 v33, v33
    v_add_f32 v34, 1.0, v34
    v_rcp_f32 v34, v34
    v_add_f32 v35, 1.0, v35
    v_rcp_f32 v35, v35
    v_mul_f32 v28, v28, v32
    v_mul_f32 v29, v29, v33
    v_mul_f32 v30, v30, v34
    v_mul_f32 v31, v31, v35
    v_cvt_pk_bf16_f32 v36, v28, v29
    v_cvt_pk_bf16_f32 v37, v30, v31
    s_mov_b32 s26, 29360160
    buffer_store_dwordx2 v[36:37], v7, s[12:15], s26 offen
    v_cvt_pk_bf16_f32 v24, v60, v61
    v_lshlrev_b32 v28, 16, v24
    v_and_b32 v29, 0xffff0000, v24
    v_cvt_pk_bf16_f32 v25, v62, v63
    v_lshlrev_b32 v30, 16, v25
    v_and_b32 v31, 0xffff0000, v25
    v_mul_f32 v32, s27, v28
    v_exp_f32 v32, v32
    v_mul_f32 v33, s27, v29
    v_exp_f32 v33, v33
    v_mul_f32 v34, s27, v30
    v_exp_f32 v34, v34
    v_mul_f32 v35, s27, v31
    v_exp_f32 v35, v35
    v_add_f32 v32, 1.0, v32
    v_rcp_f32 v32, v32
    v_add_f32 v33, 1.0, v33
    v_rcp_f32 v33, v33
    v_add_f32 v34, 1.0, v34
    v_rcp_f32 v34, v34
    v_add_f32 v35, 1.0, v35
    v_rcp_f32 v35, v35
    v_mul_f32 v28, v28, v32
    v_mul_f32 v29, v29, v33
    v_mul_f32 v30, v30, v34
    v_mul_f32 v31, v31, v35
    v_cvt_pk_bf16_f32 v38, v28, v29
    v_cvt_pk_bf16_f32 v39, v30, v31
    s_mov_b32 s26, 29360176
    buffer_store_dwordx2 v[38:39], v7, s[12:15], s26 offen
    v_cvt_pk_bf16_f32 v24, v64, v65
    v_lshlrev_b32 v28, 16, v24
    v_and_b32 v29, 0xffff0000, v24
    v_cvt_pk_bf16_f32 v25, v66, v67
    v_lshlrev_b32 v30, 16, v25
    v_and_b32 v31, 0xffff0000, v25
    v_mul_f32 v32, s27, v28
    v_exp_f32 v32, v32
    v_mul_f32 v33, s27, v29
    v_exp_f32 v33, v33
    v_mul_f32 v34, s27, v30
    v_exp_f32 v34, v34
    v_mul_f32 v35, s27, v31
    v_exp_f32 v35, v35
    v_add_f32 v32, 1.0, v32
    v_rcp_f32 v32, v32
    v_add_f32 v33, 1.0, v33
    v_rcp_f32 v33, v33
    v_add_f32 v34, 1.0, v34
    v_rcp_f32 v34, v34
    v_add_f32 v35, 1.0, v35
    v_rcp_f32 v35, v35
    v_mul_f32 v28, v28, v32
    v_mul_f32 v29, v29, v33
    v_mul_f32 v30, v30, v34
    v_mul_f32 v31, v31, v35
    v_cvt_pk_bf16_f32 v36, v28, v29
    v_cvt_pk_bf16_f32 v37, v30, v31
    s_mov_b32 s26, 29392896
    buffer_store_dwordx2 v[36:37], v7, s[12:15], s26 offen
    v_cvt_pk_bf16_f32 v24, v68, v69
    v_lshlrev_b32 v28, 16, v24
    v_and_b32 v29, 0xffff0000, v24
    v_cvt_pk_bf16_f32 v25, v70, v71
    v_lshlrev_b32 v30, 16, v25
    v_and_b32 v31, 0xffff0000, v25
    v_mul_f32 v32, s27, v28
    v_exp_f32 v32, v32
    v_mul_f32 v33, s27, v29
    v_exp_f32 v33, v33
    v_mul_f32 v34, s27, v30
    v_exp_f32 v34, v34
    v_mul_f32 v35, s27, v31
    v_exp_f32 v35, v35
    v_add_f32 v32, 1.0, v32
    v_rcp_f32 v32, v32
    v_add_f32 v33, 1.0, v33
    v_rcp_f32 v33, v33
    v_add_f32 v34, 1.0, v34
    v_rcp_f32 v34, v34
    v_add_f32 v35, 1.0, v35
    v_rcp_f32 v35, v35
    v_mul_f32 v28, v28, v32
    v_mul_f32 v29, v29, v33
    v_mul_f32 v30, v30, v34
    v_mul_f32 v31, v31, v35
    v_cvt_pk_bf16_f32 v38, v28, v29
    v_cvt_pk_bf16_f32 v39, v30, v31
    s_mov_b32 s26, 29392912
    buffer_store_dwordx2 v[38:39], v7, s[12:15], s26 offen
    v_cvt_pk_bf16_f32 v24, v72, v73
    v_lshlrev_b32 v28, 16, v24
    v_and_b32 v29, 0xffff0000, v24
    v_cvt_pk_bf16_f32 v25, v74, v75
    v_lshlrev_b32 v30, 16, v25
    v_and_b32 v31, 0xffff0000, v25
    v_mul_f32 v32, s27, v28
    v_exp_f32 v32, v32
    v_mul_f32 v33, s27, v29
    v_exp_f32 v33, v33
    v_mul_f32 v34, s27, v30
    v_exp_f32 v34, v34
    v_mul_f32 v35, s27, v31
    v_exp_f32 v35, v35
    v_add_f32 v32, 1.0, v32
    v_rcp_f32 v32, v32
    v_add_f32 v33, 1.0, v33
    v_rcp_f32 v33, v33
    v_add_f32 v34, 1.0, v34
    v_rcp_f32 v34, v34
    v_add_f32 v35, 1.0, v35
    v_rcp_f32 v35, v35
    v_mul_f32 v28, v28, v32
    v_mul_f32 v29, v29, v33
    v_mul_f32 v30, v30, v34
    v_mul_f32 v31, v31, v35
    v_cvt_pk_bf16_f32 v36, v28, v29
    v_cvt_pk_bf16_f32 v37, v30, v31
    s_mov_b32 s26, 29392928
    buffer_store_dwordx2 v[36:37], v7, s[12:15], s26 offen
    v_cvt_pk_bf16_f32 v24, v76, v77
    v_lshlrev_b32 v28, 16, v24
    v_and_b32 v29, 0xffff0000, v24
    v_cvt_pk_bf16_f32 v25, v78, v79
    v_lshlrev_b32 v30, 16, v25
    v_and_b32 v31, 0xffff0000, v25
    v_mul_f32 v32, s27, v28
    v_exp_f32 v32, v32
    v_mul_f32 v33, s27, v29
    v_exp_f32 v33, v33
    v_mul_f32 v34, s27, v30
    v_exp_f32 v34, v34
    v_mul_f32 v35, s27, v31
    v_exp_f32 v35, v35
    v_add_f32 v32, 1.0, v32
    v_rcp_f32 v32, v32
    v_add_f32 v33, 1.0, v33
    v_rcp_f32 v33, v33
    v_add_f32 v34, 1.0, v34
    v_rcp_f32 v34, v34
    v_add_f32 v35, 1.0, v35
    v_rcp_f32 v35, v35
    v_mul_f32 v28, v28, v32
    v_mul_f32 v29, v29, v33
    v_mul_f32 v30, v30, v34
    v_mul_f32 v31, v31, v35
    v_cvt_pk_bf16_f32 v38, v28, v29
    v_cvt_pk_bf16_f32 v39, v30, v31
    s_mov_b32 s26, 29392944
    buffer_store_dwordx2 v[38:39], v7, s[12:15], s26 offen
Lend_g2:
    s_endpgm
Lrole_l2_1:
    s_sub_u32 s2, s2, 128
    s_cmp_ge_u32 s2, 257
    s_cbranch_scc1 Lend_k2
    s_load_dwordx2 s[6:7], s[0:1], 64
    s_waitcnt lgkmcnt(0)
    s_mov_b32 s12, s6
    s_and_b32 s13, s7, 0xffff
    s_mov_b32 s14, 268435456
    s_mov_b32 s15, 0x00020000
    s_mov_b32 s16, 0x3f3504f3
    s_lshl_b32 s17, s2, 14
    v_lshlrev_b32 v1, 3, v0
    v_add_u32 v1, s17, v1
    s_mov_b32 s18, 2097152
    buffer_load_dwordx2 v[8:9], v1, s[12:15], s18 offen
    s_mov_b32 s18, 2099200
    buffer_load_dwordx2 v[10:11], v1, s[12:15], s18 offen
    s_mov_b32 s18, 2101248
    buffer_load_dwordx2 v[12:13], v1, s[12:15], s18 offen
    s_mov_b32 s18, 2103296
    buffer_load_dwordx2 v[14:15], v1, s[12:15], s18 offen
    s_mov_b32 s18, 2105344
    buffer_load_dwordx2 v[16:17], v1, s[12:15], s18 offen
    s_mov_b32 s18, 2107392
    buffer_load_dwordx2 v[18:19], v1, s[12:15], s18 offen
    s_mov_b32 s18, 2109440
    buffer_load_dwordx2 v[20:21], v1, s[12:15], s18 offen
    s_mov_b32 s18, 2111488
    buffer_load_dwordx2 v[22:23], v1, s[12:15], s18 offen
    s_lshl_b32 s17, s2, 13
    v_lshlrev_b32 v2, 2, v0
    v_add_u32 v2, s17, v2
    s_mov_b32 s19, 14680064
    buffer_load_dword v24, v2, s[12:15], s19 offen
    s_mov_b32 s19, 14681088
    buffer_load_dword v25, v2, s[12:15], s19 offen
    s_mov_b32 s19, 14682112
    buffer_load_dword v26, v2, s[12:15], s19 offen
    s_mov_b32 s19, 14683136
    buffer_load_dword v27, v2, s[12:15], s19 offen
    s_mov_b32 s19, 14684160
    buffer_load_dword v28, v2, s[12:15], s19 offen
    s_mov_b32 s19, 14685184
    buffer_load_dword v29, v2, s[12:15], s19 offen
    s_mov_b32 s19, 14686208
    buffer_load_dword v30, v2, s[12:15], s19 offen
    s_mov_b32 s19, 14687232
    buffer_load_dword v31, v2, s[12:15], s19 offen
    v_lshlrev_b32 v3, 3, v0
    s_waitcnt vmcnt(8)
    v_add_f32 v50, v8, v16
    v_add_f32 v51, v9, v17
    v_sub_f32 v52, v8, v16
    v_sub_f32 v53, v9, v17
    v_add_f32 v54, v10, v18
    v_add_f32 v55, v11, v19
    v_sub_f32 v56, v10, v18
    v_sub_f32 v57, v11, v19
    v_add_f32 v58, v12, v20
    v_add_f32 v59, v13, v21
    v_sub_f32 v60, v12, v20
    v_sub_f32 v61, v13, v21
    v_add_f32 v62, v14, v22
    v_add_f32 v63, v15, v23
    v_sub_f32 v64, v14, v22
    v_sub_f32 v65, v15, v23
    v_add_f32 v66, v56, v57
    v_sub_f32 v67, v57, v56
    v_mul_f32 v66, s16, v66
    v_mul_f32 v67, s16, v67
    v_sub_f32 v68, v65, v64
    v_add_f32 v69, v64, v65
    v_mul_f32 v68, s16, v68
    v_mul_f32_e64 v69, -v69, s16
    v_add_f32 v70, v50, v58
    v_add_f32 v71, v51, v59
    v_sub_f32 v72, v50, v58
    v_sub_f32 v73, v51, v59
    v_add_f32 v74, v54, v62
    v_add_f32 v75, v55, v63
    v_sub_f32 v76, v54, v62
    v_sub_f32 v77, v55, v63
    v_add_f32 v34, v70, v74
    v_add_f32 v35, v71, v75
    v_sub_f32 v42, v70, v74
    v_sub_f32 v43, v71, v75
    v_add_f32 v38, v72, v77
    v_sub_f32 v39, v73, v76
    v_sub_f32 v46, v72, v77
    v_add_f32 v47, v73, v76
    v_add_f32 v78, v52, v61
    v_sub_f32 v79, v53, v60
    v_sub_f32 v80, v52, v61
    v_add_f32 v81, v53, v60
    v_add_f32 v82, v66, v68
    v_add_f32 v83, v67, v69
    v_sub_f32 v84, v66, v68
    v_sub_f32 v85, v67, v69
    v_add_f32 v36, v78, v82
    v_add_f32 v37, v79, v83
    v_sub_f32 v44, v78, v82
    v_sub_f32 v45, v79, v83
    v_add_f32 v40, v80, v85
    v_sub_f32 v41, v81, v84
    v_sub_f32 v48, v80, v85
    v_add_f32 v49, v81, v84
    v_lshlrev_b32 v32, 6, v0
    ds_write_b64 v32, v[34:35] offset:0
    ds_write_b64 v32, v[36:37] offset:8
    ds_write_b64 v32, v[38:39] offset:16
    ds_write_b64 v32, v[40:41] offset:24
    ds_write_b64 v32, v[42:43] offset:32
    ds_write_b64 v32, v[44:45] offset:40
    ds_write_b64 v32, v[46:47] offset:48
    ds_write_b64 v32, v[48:49] offset:56
    s_waitcnt lgkmcnt(0)
    s_barrier
    ds_read_b64 v[34:35], v3 offset:0
    ds_read_b64 v[36:37], v3 offset:2048
    ds_read_b64 v[38:39], v3 offset:4096
    ds_read_b64 v[40:41], v3 offset:6144
    ds_read_b64 v[42:43], v3 offset:8192
    ds_read_b64 v[44:45], v3 offset:10240
    ds_read_b64 v[46:47], v3 offset:12288
    ds_read_b64 v[48:49], v3 offset:14336
    s_waitcnt lgkmcnt(0)
    v_and_b32 v33, 7, v0
    v_cvt_f32_u32 v86, v33
    v_mul_f32 v86, 0xbc800000, v86
    v_mov_b32 v87, v86
    v_cos_f32 v88, v87
    v_sin_f32 v89, v87
    v_mul_f32 v90, v36, v88
    v_mul_f32 v91, v36, v89
    v_fma_f32 v90, -v37, v89, v90
    v_fma_f32 v91, v37, v88, v91
    v_mul_f32 v92, 0x40000000, v86
    v_cos_f32 v93, v92
    v_sin_f32 v94, v92
    v_mul_f32 v95, v38, v93
    v_mul_f32 v96, v38, v94
    v_fma_f32 v95, -v39, v94, v95
    v_fma_f32 v96, v39, v93, v96
    v_mul_f32 v97, 0x40400000, v86
    v_cos_f32 v98, v97
    v_sin_f32 v99, v97
    v_mul_f32 v100, v40, v98
    v_mul_f32 v101, v40, v99
    v_fma_f32 v100, -v41, v99, v100
    v_fma_f32 v101, v41, v98, v101
    v_mul_f32 v102, 0x40800000, v86
    v_cos_f32 v103, v102
    v_sin_f32 v104, v102
    v_mul_f32 v105, v42, v103
    v_mul_f32 v106, v42, v104
    v_fma_f32 v105, -v43, v104, v105
    v_fma_f32 v106, v43, v103, v106
    v_mul_f32 v107, 0x40a00000, v86
    v_cos_f32 v108, v107
    v_sin_f32 v109, v107
    v_mul_f32 v110, v44, v108
    v_mul_f32 v111, v44, v109
    v_fma_f32 v110, -v45, v109, v110
    v_fma_f32 v111, v45, v108, v111
    v_mul_f32 v112, 0x40c00000, v86
    v_cos_f32 v113, v112
    v_sin_f32 v114, v112
    v_mul_f32 v115, v46, v113
    v_mul_f32 v116, v46, v114
    v_fma_f32 v115, -v47, v114, v115
    v_fma_f32 v116, v47, v113, v116
    v_mul_f32 v117, 0x40e00000, v86
    v_cos_f32 v118, v117
    v_sin_f32 v119, v117
    v_mul_f32 v120, v48, v118
    v_mul_f32 v121, v48, v119
    v_fma_f32 v120, -v49, v119, v120
    v_fma_f32 v121, v49, v118, v121
    v_add_f32 v122, v34, v105
    v_add_f32 v123, v35, v106
    v_sub_f32 v124, v34, v105
    v_sub_f32 v125, v35, v106
    v_add_f32 v126, v90, v110
    v_add_f32 v127, v91, v111
    v_sub_f32 v128, v90, v110
    v_sub_f32 v129, v91, v111
    v_add_f32 v130, v95, v115
    v_add_f32 v131, v96, v116
    v_sub_f32 v132, v95, v115
    v_sub_f32 v133, v96, v116
    v_add_f32 v134, v100, v120
    v_add_f32 v135, v101, v121
    v_sub_f32 v136, v100, v120
    v_sub_f32 v137, v101, v121
    v_add_f32 v138, v128, v129
    v_sub_f32 v139, v129, v128
    v_mul_f32 v138, s16, v138
    v_mul_f32 v139, s16, v139
    v_sub_f32 v140, v137, v136
    v_add_f32 v141, v136, v137
    v_mul_f32 v140, s16, v140
    v_mul_f32_e64 v141, -v141, s16
    v_add_f32 v142, v122, v130
    v_add_f32 v143, v123, v131
    v_sub_f32 v144, v122, v130
    v_sub_f32 v145, v123, v131
    v_add_f32 v146, v126, v134
    v_add_f32 v147, v127, v135
    v_sub_f32 v148, v126, v134
    v_sub_f32 v149, v127, v135
    v_add_f32 v8, v142, v146
    v_add_f32 v9, v143, v147
    v_sub_f32 v16, v142, v146
    v_sub_f32 v17, v143, v147
    v_add_f32 v12, v144, v149
    v_sub_f32 v13, v145, v148
    v_sub_f32 v20, v144, v149
    v_add_f32 v21, v145, v148
    v_add_f32 v150, v124, v133
    v_sub_f32 v151, v125, v132
    v_sub_f32 v152, v124, v133
    v_add_f32 v153, v125, v132
    v_add_f32 v154, v138, v140
    v_add_f32 v155, v139, v141
    v_sub_f32 v156, v138, v140
    v_sub_f32 v157, v139, v141
    v_add_f32 v10, v150, v154
    v_add_f32 v11, v151, v155
    v_sub_f32 v18, v150, v154
    v_sub_f32 v19, v151, v155
    v_add_f32 v14, v152, v157
    v_sub_f32 v15, v153, v156
    v_sub_f32 v22, v152, v157
    v_add_f32 v23, v153, v156
    v_lshrrev_b32 v32, 3, v0
    v_lshlrev_b32 v32, 9, v32
    v_lshl_add_u32 v32, v33, 3, v32
    ds_write_b64 v32, v[8:9] offset:16384
    ds_write_b64 v32, v[10:11] offset:16448
    ds_write_b64 v32, v[12:13] offset:16512
    ds_write_b64 v32, v[14:15] offset:16576
    ds_write_b64 v32, v[16:17] offset:16640
    ds_write_b64 v32, v[18:19] offset:16704
    ds_write_b64 v32, v[20:21] offset:16768
    ds_write_b64 v32, v[22:23] offset:16832
    s_waitcnt lgkmcnt(0)
    s_barrier
    ds_read_b64 v[8:9], v3 offset:16384
    ds_read_b64 v[10:11], v3 offset:18432
    ds_read_b64 v[12:13], v3 offset:20480
    ds_read_b64 v[14:15], v3 offset:22528
    ds_read_b64 v[16:17], v3 offset:24576
    ds_read_b64 v[18:19], v3 offset:26624
    ds_read_b64 v[20:21], v3 offset:28672
    ds_read_b64 v[22:23], v3 offset:30720
    s_waitcnt lgkmcnt(0)
    v_and_b32 v33, 63, v0
    v_cvt_f32_u32 v158, v33
    v_mul_f32 v158, 0xbb000000, v158
    v_mov_b32 v159, v158
    v_cos_f32 v160, v159
    v_sin_f32 v161, v159
    v_mul_f32 v162, v10, v160
    v_mul_f32 v163, v10, v161
    v_fma_f32 v162, -v11, v161, v162
    v_fma_f32 v163, v11, v160, v163
    v_mul_f32 v164, 0x40000000, v158
    v_cos_f32 v165, v164
    v_sin_f32 v166, v164
    v_mul_f32 v167, v12, v165
    v_mul_f32 v168, v12, v166
    v_fma_f32 v167, -v13, v166, v167
    v_fma_f32 v168, v13, v165, v168
    v_mul_f32 v169, 0x40400000, v158
    v_cos_f32 v170, v169
    v_sin_f32 v171, v169
    v_mul_f32 v172, v14, v170
    v_mul_f32 v173, v14, v171
    v_fma_f32 v172, -v15, v171, v172
    v_fma_f32 v173, v15, v170, v173
    v_mul_f32 v174, 0x40800000, v158
    v_cos_f32 v175, v174
    v_sin_f32 v176, v174
    v_mul_f32 v177, v16, v175
    v_mul_f32 v178, v16, v176
    v_fma_f32 v177, -v17, v176, v177
    v_fma_f32 v178, v17, v175, v178
    v_mul_f32 v179, 0x40a00000, v158
    v_cos_f32 v180, v179
    v_sin_f32 v181, v179
    v_mul_f32 v182, v18, v180
    v_mul_f32 v183, v18, v181
    v_fma_f32 v182, -v19, v181, v182
    v_fma_f32 v183, v19, v180, v183
    v_mul_f32 v184, 0x40c00000, v158
    v_cos_f32 v185, v184
    v_sin_f32 v186, v184
    v_mul_f32 v187, v20, v185
    v_mul_f32 v188, v20, v186
    v_fma_f32 v187, -v21, v186, v187
    v_fma_f32 v188, v21, v185, v188
    v_mul_f32 v189, 0x40e00000, v158
    v_cos_f32 v190, v189
    v_sin_f32 v191, v189
    v_mul_f32 v192, v22, v190
    v_mul_f32 v193, v22, v191
    v_fma_f32 v192, -v23, v191, v192
    v_fma_f32 v193, v23, v190, v193
    v_add_f32 v194, v8, v177
    v_add_f32 v195, v9, v178
    v_sub_f32 v196, v8, v177
    v_sub_f32 v197, v9, v178
    v_add_f32 v198, v162, v182
    v_add_f32 v199, v163, v183
    v_sub_f32 v56, v162, v182
    v_sub_f32 v57, v163, v183
    v_add_f32 v64, v167, v187
    v_add_f32 v65, v168, v188
    v_sub_f32 v50, v167, v187
    v_sub_f32 v51, v168, v188
    v_add_f32 v58, v172, v192
    v_add_f32 v59, v173, v193
    v_sub_f32 v54, v172, v192
    v_sub_f32 v55, v173, v193
    v_add_f32 v62, v56, v57
    v_sub_f32 v63, v57, v56
    v_mul_f32 v62, s16, v62
    v_mul_f32 v63, s16, v63
    v_sub_f32 v70, v55, v54
    v_add_f32 v71, v54, v55
    v_mul_f32 v70, s16, v70
    v_mul_f32_e64 v71, -v71, s16
    v_add_f32 v74, v194, v64
    v_add_f32 v75, v195, v65
    v_sub_f32 v72, v194, v64
    v_sub_f32 v73, v195, v65
    v_add_f32 v76, v198, v58
    v_add_f32 v77, v199, v59
    v_sub_f32 v52, v198, v58
    v_sub_f32 v53, v199, v59
    v_add_f32 v10, v74, v76
    v_add_f32 v11, v75, v77
    v_sub_f32 v18, v74, v76
    v_sub_f32 v19, v75, v77
    v_add_f32 v14, v72, v53
    v_sub_f32 v15, v73, v52
    v_sub_f32 v22, v72, v53
    v_add_f32 v23, v73, v52
    v_add_f32 v60, v196, v51
    v_sub_f32 v61, v197, v50
    v_sub_f32 v66, v196, v51
    v_add_f32 v67, v197, v50
    v_add_f32 v68, v62, v70
    v_add_f32 v69, v63, v71
    v_sub_f32 v78, v62, v70
    v_sub_f32 v79, v63, v71
    v_add_f32 v12, v60, v68
    v_add_f32 v13, v61, v69
    v_sub_f32 v20, v60, v68
    v_sub_f32 v21, v61, v69
    v_add_f32 v16, v66, v79
    v_sub_f32 v17, v67, v78
    v_sub_f32 v34, v66, v79
    v_add_f32 v35, v67, v78
    v_lshrrev_b32 v32, 6, v0
    v_lshlrev_b32 v32, 12, v32
    v_lshl_add_u32 v32, v33, 3, v32
    ds_write_b64 v32, v[10:11] offset:0
    ds_write_b64 v32, v[12:13] offset:512
    ds_write_b64 v32, v[14:15] offset:1024
    ds_write_b64 v32, v[16:17] offset:1536
    ds_write_b64 v32, v[18:19] offset:2048
    ds_write_b64 v32, v[20:21] offset:2560
    ds_write_b64 v32, v[22:23] offset:3072
    ds_write_b64 v32, v[34:35] offset:3584
    s_waitcnt lgkmcnt(0)
    s_barrier
    ds_read_b64 v[10:11], v3 offset:0
    ds_read_b64 v[12:13], v3 offset:2048
    ds_read_b64 v[14:15], v3 offset:4096
    ds_read_b64 v[16:17], v3 offset:6144
    ds_read_b64 v[18:19], v3 offset:8192
    ds_read_b64 v[20:21], v3 offset:10240
    ds_read_b64 v[22:23], v3 offset:12288
    ds_read_b64 v[34:35], v3 offset:14336
    s_waitcnt lgkmcnt(0)
    v_mov_b32 v33, v0
    v_cvt_f32_u32 v82, v33
    v_mul_f32 v82, 0xba000000, v82
    v_mov_b32 v83, v82
    v_cos_f32 v80, v83
    v_sin_f32 v81, v83
    v_mul_f32 v84, v14, v80
    v_mul_f32 v85, v14, v81
    v_fma_f32 v84, -v15, v81, v84
    v_fma_f32 v85, v15, v80, v85
    v_mul_f32 v36, 0x40000000, v82
    v_cos_f32 v37, v36
    v_sin_f32 v87, v36
    v_mul_f32 v88, v18, v37
    v_mul_f32 v89, v18, v87
    v_fma_f32 v88, -v19, v87, v88
    v_fma_f32 v89, v19, v37, v89
    v_mul_f32 v38, 0x40400000, v82
    v_cos_f32 v39, v38
    v_sin_f32 v92, v38
    v_mul_f32 v93, v22, v39
    v_mul_f32 v94, v22, v92
    v_fma_f32 v93, -v23, v92, v93
    v_fma_f32 v94, v23, v39, v94
    v_add_f32 v40, v10, v88
    v_add_f32 v41, v11, v89
    v_sub_f32 v97, v10, v88
    v_sub_f32 v98, v11, v89
    v_add_f32 v99, v84, v93
    v_add_f32 v42, v85, v94
    v_sub_f32 v43, v84, v93
    v_sub_f32 v102, v85, v94
    v_add_f32 v103, v40, v99
    v_add_f32 v104, v41, v42
    v_sub_f32 v44, v40, v99
    v_sub_f32 v45, v41, v42
    v_add_f32 v107, v97, v102
    v_sub_f32 v108, v98, v43
    v_sub_f32 v109, v97, v102
    v_add_f32 v46, v98, v43
    v_add_u32 v33, 256, v0
    v_cvt_f32_u32 v47, v33
    v_mul_f32 v47, 0xba000000, v47
    v_mov_b32 v112, v47
    v_cos_f32 v113, v112
    v_sin_f32 v114, v112
    v_mul_f32 v48, v16, v113
    v_mul_f32 v49, v16, v114
    v_fma_f32 v48, -v17, v114, v48
    v_fma_f32 v49, v17, v113, v49
    v_mul_f32 v117, 0x40000000, v47
    v_cos_f32 v118, v117
    v_sin_f32 v119, v117
    v_mul_f32 v86, v20, v118
    v_mul_f32 v105, v20, v119
    v_fma_f32 v86, -v21, v119, v86
    v_fma_f32 v105, v21, v118, v105
    v_mul_f32 v106, 0x40400000, v47
    v_cos_f32 v90, v106
    v_sin_f32 v91, v106
    v_mul_f32 v110, v34, v90
    v_mul_f32 v111, v34, v91
    v_fma_f32 v110, -v35, v91, v110
    v_fma_f32 v111, v35, v90, v111
    v_add_f32 v95, v12, v86
    v_add_f32 v96, v13, v105
    v_sub_f32 v115, v12, v86
    v_sub_f32 v116, v13, v105
    v_add_f32 v100, v48, v110
    v_add_f32 v101, v49, v111
    v_sub_f32 v120, v48, v110
    v_sub_f32 v121, v49, v111
    v_add_f32 v128, v95, v100
    v_add_f32 v129, v96, v101
    v_sub_f32 v136, v95, v100
    v_sub_f32 v137, v96, v101
    v_add_f32 v122, v115, v121
    v_sub_f32 v123, v116, v120
    v_sub_f32 v130, v115, v121
    v_add_f32 v131, v116, v120
    s_waitcnt vmcnt(0)
    v_lshlrev_b32 v126, 16, v24
    v_and_b32 v127, 0xffff0000, v24
    v_mul_f32 v126, 0x35800000, v126
    v_mul_f32 v127, 0x35800000, v127
    v_mul_f32 v134, v103, v126
    v_mul_f32 v135, v103, v127
    v_fma_f32 v134, -v104, v127, v134
    v_fma_f32 v135, v104, v126, v135
    v_lshlrev_b32 v142, 16, v25
    v_and_b32 v143, 0xffff0000, v25
    v_mul_f32 v142, 0x35800000, v142
    v_mul_f32 v143, 0x35800000, v143
    v_mul_f32 v146, v128, v142
    v_mul_f32 v147, v128, v143
    v_fma_f32 v146, -v129, v143, v146
    v_fma_f32 v147, v129, v142, v147
    v_lshlrev_b32 v144, 16, v26
    v_and_b32 v145, 0xffff0000, v26
    v_mul_f32 v144, 0x35800000, v144
    v_mul_f32 v145, 0x35800000, v145
    v_mul_f32 v148, v107, v144
    v_mul_f32 v149, v107, v145
    v_fma_f32 v148, -v108, v145, v148
    v_fma_f32 v149, v108, v144, v149
    v_lshlrev_b32 v124, 16, v27
    v_and_b32 v125, 0xffff0000, v27
    v_mul_f32 v124, 0x35800000, v124
    v_mul_f32 v125, 0x35800000, v125
    v_mul_f32 v132, v122, v124
    v_mul_f32 v133, v122, v125
    v_fma_f32 v132, -v123, v125, v132
    v_fma_f32 v133, v123, v124, v133
    v_lshlrev_b32 v138, 16, v28
    v_and_b32 v139, 0xffff0000, v28
    v_mul_f32 v138, 0x35800000, v138
    v_mul_f32 v139, 0x35800000, v139
    v_mul_f32 v140, v44, v138
    v_mul_f32 v141, v44, v139
    v_fma_f32 v140, -v45, v139, v140
    v_fma_f32 v141, v45, v138, v141
    v_lshlrev_b32 v150, 16, v29
    v_and_b32 v151, 0xffff0000, v29
    v_mul_f32 v150, 0x35800000, v150
    v_mul_f32 v151, 0x35800000, v151
    v_mul_f32 v154, v136, v150
    v_mul_f32 v155, v136, v151
    v_fma_f32 v154, -v137, v151, v154
    v_fma_f32 v155, v137, v150, v155
    v_lshlrev_b32 v152, 16, v30
    v_and_b32 v153, 0xffff0000, v30
    v_mul_f32 v152, 0x35800000, v152
    v_mul_f32 v153, 0x35800000, v153
    v_mul_f32 v156, v109, v152
    v_mul_f32 v157, v109, v153
    v_fma_f32 v156, -v46, v153, v156
    v_fma_f32 v157, v46, v152, v157
    v_lshlrev_b32 v159, 16, v31
    v_and_b32 v160, 0xffff0000, v31
    v_mul_f32 v159, 0x35800000, v159
    v_mul_f32 v160, 0x35800000, v160
    v_mul_f32 v161, v130, v159
    v_mul_f32 v164, v130, v160
    v_fma_f32 v161, -v131, v160, v161
    v_fma_f32 v164, v131, v159, v164
    v_add_f32 v169, v134, v140
    v_add_f32 v170, v135, v141
    v_sub_f32 v171, v134, v140
    v_sub_f32 v174, v135, v141
    v_add_f32 v175, v146, v154
    v_add_f32 v176, v147, v155
    v_sub_f32 v179, v146, v154
    v_sub_f32 v180, v147, v155
    v_add_f32 v181, v148, v156
    v_add_f32 v184, v149, v157
    v_sub_f32 v185, v148, v156
    v_sub_f32 v186, v149, v157
    v_add_f32 v189, v132, v161
    v_add_f32 v190, v133, v164
    v_sub_f32 v191, v132, v161
    v_sub_f32 v158, v133, v164
    v_sub_f32 v177, v179, v180
    v_add_f32 v178, v179, v180
    v_mul_f32 v177, s16, v177
    v_mul_f32 v178, s16, v178
    v_add_f32 v162, v191, v158
    v_sub_f32 v163, v191, v158
    v_mul_f32_e64 v162, -v162, s16
    v_mul_f32 v163, s16, v163
    v_add_f32 v182, v169, v181
    v_add_f32 v183, v170, v184
    v_sub_f32 v167, v169, v181
    v_sub_f32 v168, v170, v184
    v_add_f32 v187, v175, v189
    v_add_f32 v188, v176, v190
    v_sub_f32 v172, v175, v189
    v_sub_f32 v173, v176, v190
    v_add_f32 v8, v182, v187
    v_add_f32 v9, v183, v188
    v_sub_f32 v16, v182, v187
    v_sub_f32 v17, v183, v188
    v_sub_f32 v12, v167, v173
    v_add_f32 v13, v168, v172
    v_add_f32 v20, v167, v173
    v_sub_f32 v21, v168, v172
    v_sub_f32 v192, v171, v186
    v_add_f32 v193, v174, v185
    v_add_f32 v56, v171, v186
    v_sub_f32 v57, v174, v185
    v_add_f32 v54, v177, v162
    v_add_f32 v55, v178, v163
    v_sub_f32 v194, v177, v162
    v_sub_f32 v195, v178, v163
    v_add_f32 v10, v192, v54
    v_add_f32 v11, v193, v55
    v_sub_f32 v18, v192, v54
    v_sub_f32 v19, v193, v55
    v_sub_f32 v14, v56, v195
    v_add_f32 v15, v57, v194
    v_add_f32 v22, v56, v195
    v_sub_f32 v23, v57, v194
    v_lshlrev_b32 v165, 6, v0
    ds_write_b64 v165, v[8:9] offset:16384
    ds_write_b64 v165, v[10:11] offset:16392
    ds_write_b64 v165, v[12:13] offset:16400
    ds_write_b64 v165, v[14:15] offset:16408
    ds_write_b64 v165, v[16:17] offset:16416
    ds_write_b64 v165, v[18:19] offset:16424
    ds_write_b64 v165, v[20:21] offset:16432
    ds_write_b64 v165, v[22:23] offset:16440
    s_waitcnt lgkmcnt(0)
    s_barrier
    ds_read_b64 v[8:9], v3 offset:16384
    ds_read_b64 v[10:11], v3 offset:18432
    ds_read_b64 v[12:13], v3 offset:20480
    ds_read_b64 v[14:15], v3 offset:22528
    ds_read_b64 v[16:17], v3 offset:24576
    ds_read_b64 v[18:19], v3 offset:26624
    ds_read_b64 v[20:21], v3 offset:28672
    ds_read_b64 v[22:23], v3 offset:30720
    s_waitcnt lgkmcnt(0)
    v_and_b32 v166, 7, v0
    v_cvt_f32_u32 v64, v166
    v_mul_f32 v64, 0x3c800000, v64
    v_mov_b32 v65, v64
    v_cos_f32 v198, v65
    v_sin_f32 v199, v65
    v_mul_f32 v58, v10, v198
    v_mul_f32 v59, v10, v199
    v_fma_f32 v58, -v11, v199, v58
    v_fma_f32 v59, v11, v198, v59
    v_mul_f32 v74, 0x40000000, v64
    v_cos_f32 v75, v74
    v_sin_f32 v76, v74
    v_mul_f32 v77, v12, v75
    v_mul_f32 v72, v12, v76
    v_fma_f32 v77, -v13, v76, v77
    v_fma_f32 v72, v13, v75, v72
    v_mul_f32 v73, 0x40400000, v64
    v_cos_f32 v52, v73
    v_sin_f32 v53, v73
    v_mul_f32 v196, v14, v52
    v_mul_f32 v197, v14, v53
    v_fma_f32 v196, -v15, v53, v196
    v_fma_f32 v197, v15, v52, v197
    v_mul_f32 v50, 0x40800000, v64
    v_cos_f32 v51, v50
    v_sin_f32 v62, v50
    v_mul_f32 v63, v16, v51
    v_mul_f32 v70, v16, v62
    v_fma_f32 v63, -v17, v62, v63
    v_fma_f32 v70, v17, v51, v70
    v_mul_f32 v71, 0x40a00000, v64
    v_cos_f32 v60, v71
    v_sin_f32 v61, v71
    v_mul_f32 v68, v18, v60
    v_mul_f32 v69, v18, v61
    v_fma_f32 v68, -v19, v61, v68
    v_fma_f32 v69, v19, v60, v69
    v_mul_f32 v66, 0x40c00000, v64
    v_cos_f32 v67, v66
    v_sin_f32 v78, v66
    v_mul_f32 v79, v20, v67
    v_mul_f32 v83, v20, v78
    v_fma_f32 v79, -v21, v78, v79
    v_fma_f32 v83, v21, v67, v83
    v_mul_f32 v80, 0x40e00000, v64
    v_cos_f32 v81, v80
    v_sin_f32 v36, v80
    v_mul_f32 v37, v22, v81
    v_mul_f32 v87, v22, v36
    v_fma_f32 v37, -v23, v36, v37
    v_fma_f32 v87, v23, v81, v87
    v_add_f32 v38, v8, v63
    v_add_f32 v39, v9, v70
    v_sub_f32 v92, v8, v63
    v_sub_f32 v82, v9, v70
    v_add_f32 v88, v58, v68
    v_add_f32 v89, v59, v69
    v_sub_f32 v84, v58, v68
    v_sub_f32 v85, v59, v69
    v_add_f32 v93, v77, v79
    v_add_f32 v94, v72, v83
    v_sub_f32 v40, v77, v79
    v_sub_f32 v41, v72, v83
    v_add_f32 v99, v196, v37
    v_add_f32 v42, v197, v87
    v_sub_f32 v97, v196, v37
    v_sub_f32 v98, v197, v87
    v_sub_f32 v43, v84, v85
    v_add_f32 v102, v84, v85
    v_mul_f32 v43, s16, v43
    v_mul_f32 v102, s16, v102
    v_add_f32 v112, v97, v98
    v_sub_f32 v113, v97, v98
    v_mul_f32_e64 v112, -v112, s16
    v_mul_f32 v113, s16, v113
    v_add_f32 v114, v38, v93
    v_add_f32 v117, v39, v94
    v_sub_f32 v118, v38, v93
    v_sub_f32 v119, v39, v94
    v_add_f32 v34, v88, v99
    v_add_f32 v35, v89, v42
    v_sub_f32 v106, v88, v99
    v_sub_f32 v90, v89, v42
    v_add_f32 v10, v114, v34
    v_add_f32 v11, v117, v35
    v_sub_f32 v18, v114, v34
    v_sub_f32 v19, v117, v35
    v_sub_f32 v14, v118, v90
    v_add_f32 v15, v119, v106
    v_add_f32 v22, v118, v90
    v_sub_f32 v23, v119, v106
    v_sub_f32 v91, v92, v41
    v_add_f32 v47, v82, v40
    v_add_f32 v86, v92, v41
    v_sub_f32 v105, v82, v40
    v_add_f32 v48, v43, v112
    v_add_f32 v49, v102, v113
    v_sub_f32 v110, v43, v112
    v_sub_f32 v111, v102, v113
    v_add_f32 v12, v91, v48
    v_add_f32 v13, v47, v49
    v_sub_f32 v20, v91, v48
    v_sub_f32 v21, v47, v49
    v_sub_f32 v16, v86, v111
    v_add_f32 v17, v105, v110
    v_add_f32 v24, v86, v111
    v_sub_f32 v25, v105, v110
    v_lshrrev_b32 v165, 3, v0
    v_lshlrev_b32 v165, 9, v165
    v_lshl_add_u32 v165, v166, 3, v165
    ds_write_b64 v165, v[10:11] offset:0
    ds_write_b64 v165, v[12:13] offset:64
    ds_write_b64 v165, v[14:15] offset:128
    ds_write_b64 v165, v[16:17] offset:192
    ds_write_b64 v165, v[18:19] offset:256
    ds_write_b64 v165, v[20:21] offset:320
    ds_write_b64 v165, v[22:23] offset:384
    ds_write_b64 v165, v[24:25] offset:448
    s_waitcnt lgkmcnt(0)
    s_barrier
    ds_read_b64 v[10:11], v3 offset:0
    ds_read_b64 v[12:13], v3 offset:2048
    ds_read_b64 v[14:15], v3 offset:4096
    ds_read_b64 v[16:17], v3 offset:6144
    ds_read_b64 v[18:19], v3 offset:8192
    ds_read_b64 v[20:21], v3 offset:10240
    ds_read_b64 v[22:23], v3 offset:12288
    ds_read_b64 v[24:25], v3 offset:14336
    s_waitcnt lgkmcnt(0)
    v_and_b32 v166, 63, v0
    v_cvt_f32_u32 v95, v166
    v_mul_f32 v95, 0x3b000000, v95
    v_mov_b32 v96, v95
    v_cos_f32 v100, v96
    v_sin_f32 v101, v96
    v_mul_f32 v115, v12, v100
    v_mul_f32 v116, v12, v101
    v_fma_f32 v115, -v13, v101, v115
    v_fma_f32 v116, v13, v100, v116
    v_mul_f32 v120, 0x40000000, v95
    v_cos_f32 v121, v120
    v_sin_f32 v32, v120
    v_mul_f32 v33, v14, v121
    v_mul_f32 v103, v14, v32
    v_fma_f32 v33, -v15, v32, v33
    v_fma_f32 v103, v15, v121, v103
    v_mul_f32 v104, 0x40400000, v95
    v_cos_f32 v126, v104
    v_sin_f32 v127, v104
    v_mul_f32 v128, v16, v126
    v_mul_f32 v129, v16, v127
    v_fma_f32 v128, -v17, v127, v128
    v_fma_f32 v129, v17, v126, v129
    v_mul_f32 v142, 0x40800000, v95
    v_cos_f32 v143, v142
    v_sin_f32 v107, v142
    v_mul_f32 v108, v18, v143
    v_mul_f32 v144, v18, v107
    v_fma_f32 v108, -v19, v107, v108
    v_fma_f32 v144, v19, v143, v144
    v_mul_f32 v145, 0x40a00000, v95
    v_cos_f32 v122, v145
    v_sin_f32 v123, v145
    v_mul_f32 v124, v20, v122
    v_mul_f32 v125, v20, v123
    v_fma_f32 v124, -v21, v123, v124
    v_fma_f32 v125, v21, v122, v125
    v_mul_f32 v44, 0x40c00000, v95
    v_cos_f32 v45, v44
    v_sin_f32 v138, v44
    v_mul_f32 v139, v22, v45
    v_mul_f32 v136, v22, v138
    v_fma_f32 v139, -v23, v138, v139
    v_fma_f32 v136, v23, v45, v136
    v_mul_f32 v137, 0x40e00000, v95
    v_cos_f32 v150, v137
    v_sin_f32 v151, v137
    v_mul_f32 v109, v24, v150
    v_mul_f32 v46, v24, v151
    v_fma_f32 v109, -v25, v151, v109
    v_fma_f32 v46, v25, v150, v46
    v_add_f32 v152, v10, v108
    v_add_f32 v153, v11, v144
    v_sub_f32 v130, v10, v108
    v_sub_f32 v131, v11, v144
    v_add_f32 v159, v115, v124
    v_add_f32 v160, v116, v125
    v_sub_f32 v26, v115, v124
    v_sub_f32 v27, v116, v125
    v_add_f32 v28, v33, v139
    v_add_f32 v29, v103, v136
    v_sub_f32 v30, v33, v139
    v_sub_f32 v31, v103, v136
    v_add_f32 v134, v128, v109
    v_add_f32 v135, v129, v46
    v_sub_f32 v140, v128, v109
    v_sub_f32 v141, v129, v46
    v_sub_f32 v146, v26, v27
    v_add_f32 v147, v26, v27
    v_mul_f32 v146, s16, v146
    v_mul_f32 v147, s16, v147
    v_add_f32 v154, v140, v141
    v_sub_f32 v155, v140, v141
    v_mul_f32_e64 v154, -v154, s16
    v_mul_f32 v155, s16, v155
    v_add_f32 v148, v152, v28
    v_add_f32 v149, v153, v29
    v_sub_f32 v156, v152, v28
    v_sub_f32 v157, v153, v29
    v_add_f32 v132, v159, v134
    v_add_f32 v133, v160, v135
    v_sub_f32 v161, v159, v134
    v_sub_f32 v164, v160, v135
    v_add_f32 v8, v148, v132
    v_add_f32 v9, v149, v133
    v_sub_f32 v18, v148, v132
    v_sub_f32 v19, v149, v133
    v_sub_f32 v14, v156, v164
    v_add_f32 v15, v157, v161
    v_add_f32 v22, v156, v164
    v_sub_f32 v23, v157, v161
    v_sub_f32 v179, v130, v31
    v_add_f32 v180, v131, v30
    v_add_f32 v191, v130, v31
    v_sub_f32 v158, v131, v30
    v_add_f32 v169, v146, v154
    v_add_f32 v170, v147, v155
    v_sub_f32 v181, v146, v154
    v_sub_f32 v184, v147, v155
    v_add_f32 v12, v179, v169
    v_add_f32 v13, v180, v170
    v_sub_f32 v20, v179, v169
    v_sub_f32 v21, v180, v170
    v_sub_f32 v16, v191, v184
    v_add_f32 v17, v158, v181
    v_add_f32 v24, v191, v184
    v_sub_f32 v25, v158, v181
    v_lshrrev_b32 v165, 6, v0
    v_lshlrev_b32 v165, 12, v165
    v_lshl_add_u32 v165, v166, 3, v165
    ds_write_b64 v165, v[8:9] offset:16384
    ds_write_b64 v165, v[12:13] offset:16896
    ds_write_b64 v165, v[14:15] offset:17408
    ds_write_b64 v165, v[16:17] offset:17920
    ds_write_b64 v165, v[18:19] offset:18432
    ds_write_b64 v165, v[20:21] offset:18944
    ds_write_b64 v165, v[22:23] offset:19456
    ds_write_b64 v165, v[24:25] offset:19968
    s_waitcnt lgkmcnt(0)
    s_barrier
    ds_read_b64 v[8:9], v3 offset:16384
    ds_read_b64 v[12:13], v3 offset:18432
    ds_read_b64 v[14:15], v3 offset:20480
    ds_read_b64 v[16:17], v3 offset:22528
    ds_read_b64 v[18:19], v3 offset:24576
    ds_read_b64 v[20:21], v3 offset:26624
    ds_read_b64 v[22:23], v3 offset:28672
    ds_read_b64 v[24:25], v3 offset:30720
    s_waitcnt lgkmcnt(0)
    v_mov_b32 v166, v0
    v_cvt_f32_u32 v175, v166
    v_mul_f32 v175, 0x3a000000, v175
    v_mov_b32 v176, v175
    v_cos_f32 v189, v176
    v_sin_f32 v190, v176
    v_mul_f32 v182, v14, v189
    v_mul_f32 v183, v14, v190
    v_fma_f32 v182, -v15, v190, v182
    v_fma_f32 v183, v15, v189, v183
    v_mul_f32 v187, 0x40000000, v175
    v_cos_f32 v188, v187
    v_sin_f32 v167, v187
    v_mul_f32 v168, v18, v188
    v_mul_f32 v172, v18, v167
    v_fma_f32 v168, -v19, v167, v168
    v_fma_f32 v172, v19, v188, v172
    v_mul_f32 v173, 0x40400000, v175
    v_cos_f32 v171, v173
    v_sin_f32 v174, v173
    v_mul_f32 v185, v22, v171
    v_mul_f32 v186, v22, v174
    v_fma_f32 v185, -v23, v174, v185
    v_fma_f32 v186, v23, v171, v186
    v_add_f32 v177, v8, v168
    v_add_f32 v178, v9, v172
    v_sub_f32 v162, v8, v168
    v_sub_f32 v163, v9, v172
    v_add_f32 v192, v182, v185
    v_add_f32 v193, v183, v186
    v_sub_f32 v54, v182, v185
    v_sub_f32 v55, v183, v186
    v_add_f32 v56, v177, v192
    v_add_f32 v57, v178, v193
    v_sub_f32 v194, v177, v192
    v_sub_f32 v195, v178, v193
    v_sub_f32 v65, v162, v55
    v_add_f32 v198, v163, v54
    v_add_f32 v199, v162, v55
    v_sub_f32 v74, v163, v54
    v_add_u32 v166, 256, v0
    v_cvt_f32_u32 v75, v166
    v_mul_f32 v75, 0x3a000000, v75
    v_mov_b32 v76, v75
    v_cos_f32 v73, v76
    v_sin_f32 v52, v76
    v_mul_f32 v53, v16, v73
    v_mul_f32 v50, v16, v52
    v_fma_f32 v53, -v17, v52, v53
    v_fma_f32 v50, v17, v73, v50
    v_mul_f32 v51, 0x40000000, v75
    v_cos_f32 v62, v51
    v_sin_f32 v71, v51
    v_mul_f32 v60, v20, v62
    v_mul_f32 v61, v20, v71
    v_fma_f32 v60, -v21, v71, v60
    v_fma_f32 v61, v21, v62, v61
    v_mul_f32 v66, 0x40400000, v75
    v_cos_f32 v67, v66
    v_sin_f32 v78, v66
    v_mul_f32 v80, v24, v67
    v_mul_f32 v81, v24, v78
    v_fma_f32 v80, -v25, v78, v80
    v_fma_f32 v81, v25, v67, v81
    v_add_f32 v36, v12, v60
    v_add_f32 v64, v13, v61
    v_sub_f32 v63, v12, v60
    v_sub_f32 v70, v13, v61
    v_add_f32 v58, v53, v80
    v_add_f32 v59, v50, v81
    v_sub_f32 v68, v53, v80
    v_sub_f32 v69, v50, v81
    v_add_f32 v77, v36, v58
    v_add_f32 v72, v64, v59
    v_sub_f32 v79, v36, v58
    v_sub_f32 v83, v64, v59
    v_sub_f32 v196, v63, v69
    v_add_f32 v197, v70, v68
    v_add_f32 v37, v63, v69
    v_sub_f32 v87, v70, v68
    v_mov_b32 v8, v56
    v_mov_b32 v9, v57
    s_mov_b32 s18, 8388608
    buffer_store_dwordx2 v[8:9], v1, s[12:15], s18 offen
    v_mov_b32 v10, v77
    v_mov_b32 v11, v72
    s_mov_b32 s18, 8390656
    buffer_store_dwordx2 v[10:11], v1, s[12:15], s18 offen
    v_mov_b32 v12, v65
    v_mov_b32 v13, v198
    s_mov_b32 s18, 8392704
    buffer_store_dwordx2 v[12:13], v1, s[12:15], s18 offen
    v_mov_b32 v14, v196
    v_mov_b32 v15, v197
    s_mov_b32 s18, 8394752
    buffer_store_dwordx2 v[14:15], v1, s[12:15], s18 offen
    v_mov_b32 v16, v194
    v_mov_b32 v17, v195
    s_mov_b32 s18, 8396800
    buffer_store_dwordx2 v[16:17], v1, s[12:15], s18 offen
    v_mov_b32 v18, v79
    v_mov_b32 v19, v83
    s_mov_b32 s18, 8398848
    buffer_store_dwordx2 v[18:19], v1, s[12:15], s18 offen
    v_mov_b32 v20, v199
    v_mov_b32 v21, v74
    s_mov_b32 s18, 8400896
    buffer_store_dwordx2 v[20:21], v1, s[12:15], s18 offen
    v_mov_b32 v22, v37
    v_mov_b32 v23, v87
    s_mov_b32 s18, 8402944
    buffer_store_dwordx2 v[22:23], v1, s[12:15], s18 offen
Lend_k2:
    s_endpgm
Lend_l2:
    s_endpgm
.globl k4_kernel
.p2align 8
.type k4_kernel,@function
k4_kernel:
    s_cmp_ge_u32 s2, 256
    s_cbranch_scc1 Lend_k4
    s_load_dwordx2 s[4:5], s[0:1], 0
    s_load_dwordx2 s[6:7], s[0:1], 64
    s_load_dwordx2 s[28:29], s[0:1], 48
    s_waitcnt lgkmcnt(0)
    s_mov_b32 s8, s4
    s_and_b32 s9, s5, 0xffff
    s_mov_b32 s10, 2097152
    s_mov_b32 s11, 0x00020000
    s_mov_b32 s12, s6
    s_and_b32 s13, s7, 0xffff
    s_mov_b32 s14, 268435456
    s_mov_b32 s15, 0x00020000
    s_mov_b32 s32, s28
    s_and_b32 s33, s29, 0xffff
    s_mov_b32 s34, 2097152
    s_mov_b32 s35, 0x00020000
    s_mov_b32 s16, 0x3f3504f3
    v_and_b32 v1, 63, v0
    v_lshrrev_b32 v2, 6, v0
    v_and_b32 v8, 3, v0
    v_lshrrev_b32 v9, 2, v0
    v_lshlrev_b32 v10, 4, v8
    s_lshl_b32 s17, s2, 6
    v_add_u32 v10, s17, v10
    v_mov_b32 v11, v10
    v_lshl_add_u32 v10, v9, 14, v10
    s_mov_b32 s18, 8388608
    buffer_load_dwordx4 v[12:15], v10, s[12:15], s18 offen
    s_mov_b32 s18, 9437184
    buffer_load_dwordx4 v[16:19], v10, s[12:15], s18 offen
    s_mov_b32 s18, 10485760
    buffer_load_dwordx4 v[20:23], v10, s[12:15], s18 offen
    s_mov_b32 s18, 11534336
    buffer_load_dwordx4 v[24:27], v10, s[12:15], s18 offen
    s_mov_b32 s18, 12582912
    buffer_load_dwordx4 v[28:31], v11, s[12:15], s18 offen
    v_mul_u32_u24 v32, 4352, v8
    v_add_u32 v33, 4096, v32
    v_lshl_add_u32 v32, v9, 4, v32
    s_waitcnt vmcnt(0)
    v_cmp_eq_u32 vcc, 0, v9
    s_nop 1
    v_cndmask_b32 v13, v13, 0, vcc
    v_cndmask_b32 v15, v15, 0, vcc
    v_mov_b32 v29, 0
    v_mov_b32 v31, 0
    ds_write_b128 v32, v[12:15] offset:0
    ds_write_b128 v32, v[16:19] offset:1024
    ds_write_b128 v32, v[20:23] offset:2048
    ds_write_b128 v32, v[24:27] offset:3072
    ds_write_b128 v33, v[28:31]
    s_waitcnt lgkmcnt(0)
    s_barrier
    v_mul_u32_u24 v34, 4352, v2
    v_add_u32 v35, 0, v1
    v_lshl_add_u32 v35, v35, 4, v34
    ds_read_b128 v[8:11], v35
    v_add_u32 v44, 64, v1
    v_lshl_add_u32 v44, v44, 4, v34
    ds_read_b128 v[12:15], v44
    v_add_u32 v45, 128, v1
    v_lshl_add_u32 v45, v45, 4, v34
    ds_read_b128 v[16:19], v45
    v_add_u32 v46, 192, v1
    v_lshl_add_u32 v46, v46, 4, v34
    ds_read_b128 v[20:23], v46
    v_sub_u32 v47, 256, v1
    v_lshl_add_u32 v47, v47, 4, v34
    ds_read_b128 v[24:27], v47
    v_sub_u32 v48, 192, v1
    v_lshl_add_u32 v48, v48, 4, v34
    ds_read_b128 v[28:31], v48
    v_sub_u32 v49, 128, v1
    v_lshl_add_u32 v49, v49, 4, v34
    ds_read_b128 v[36:39], v49
    v_sub_u32 v50, 64, v1
    v_lshl_add_u32 v50, v50, 4, v34
    ds_read_b128 v[40:43], v50
    s_waitcnt lgkmcnt(0)
    v_sub_f32 v51, v8, v11
    v_add_f32 v52, v9, v10
    v_sub_f32 v53, v12, v15
    v_add_f32 v54, v13, v14
    v_sub_f32 v55, v16, v19
    v_add_f32 v56, v17, v18
    v_sub_f32 v57, v20, v23
    v_add_f32 v58, v21, v22
    v_add_f32 v59, v24, v27
    v_sub_f32 v60, v26, v25
    v_add_f32 v61, v28, v31
    v_sub_f32 v62, v30, v29
    v_add_f32 v63, v36, v39
    v_sub_f32 v64, v38, v37
    v_add_f32 v65, v40, v43
    v_sub_f32 v66, v42, v41
    v_lshl_add_u32 v67, v1, 3, v34
    v_add_f32 v70, v51, v59
    v_add_f32 v71, v52, v60
    v_sub_f32 v72, v51, v59
    v_sub_f32 v73, v52, v60
    v_add_f32 v74, v53, v61
    v_add_f32 v75, v54, v62
    v_sub_f32 v76, v53, v61
    v_sub_f32 v77, v54, v62
    v_add_f32 v78, v55, v63
    v_add_f32 v79, v56, v64
    v_sub_f32 v80, v55, v63
    v_sub_f32 v81, v56, v64
    v_add_f32 v82, v57, v65
    v_add_f32 v83, v58, v66
    v_sub_f32 v84, v57, v65
    v_sub_f32 v85, v58, v66
    v_sub_f32 v86, v76, v77
    v_add_f32 v87, v76, v77
    v_mul_f32 v86, s16, v86
    v_mul_f32 v87, s16, v87
    v_add_f32 v88, v84, v85
    v_sub_f32 v89, v84, v85
    v_mul_f32_e64 v88, -v88, s16
    v_mul_f32 v89, s16, v89
    v_add_f32 v90, v70, v78
    v_add_f32 v91, v71, v79
    v_sub_f32 v92, v70, v78
    v_sub_f32 v93, v71, v79
    v_add_f32 v94, v74, v82
    v_add_f32 v95, v75, v83
    v_sub_f32 v96, v74, v82
    v_sub_f32 v97, v75, v83
    v_add_f32 v8, v90, v94
    v_add_f32 v9, v91, v95
    v_sub_f32 v16, v90, v94
    v_sub_f32 v17, v91, v95
    v_sub_f32 v12, v92, v97
    v_add_f32 v13, v93, v96
    v_add_f32 v20, v92, v97
    v_sub_f32 v21, v93, v96
    v_sub_f32 v98, v72, v81
    v_add_f32 v99, v73, v80
    v_add_f32 v100, v72, v81
    v_sub_f32 v101, v73, v80
    v_add_f32 v102, v86, v88
    v_add_f32 v103, v87, v89
    v_sub_f32 v104, v86, v88
    v_sub_f32 v105, v87, v89
    v_add_f32 v10, v98, v102
    v_add_f32 v11, v99, v103
    v_sub_f32 v18, v98, v102
    v_sub_f32 v19, v99, v103
    v_sub_f32 v14, v100, v105
    v_add_f32 v15, v101, v104
    v_add_f32 v22, v100, v105
    v_sub_f32 v23, v101, v104
    v_lshl_add_u32 v68, v1, 6, v34
    s_waitcnt lgkmcnt(0)
    ds_write_b64 v68, v[8:9] offset:0
    ds_write_b64 v68, v[10:11] offset:8
    ds_write_b64 v68, v[12:13] offset:16
    ds_write_b64 v68, v[14:15] offset:24
    ds_write_b64 v68, v[16:17] offset:32
    ds_write_b64 v68, v[18:19] offset:40
    ds_write_b64 v68, v[20:21] offset:48
    ds_write_b64 v68, v[22:23] offset:56
    s_waitcnt lgkmcnt(0)
    ds_read_b64 v[8:9], v67 offset:0
    ds_read_b64 v[10:11], v67 offset:512
    ds_read_b64 v[12:13], v67 offset:1024
    ds_read_b64 v[14:15], v67 offset:1536
    ds_read_b64 v[16:17], v67 offset:2048
    ds_read_b64 v[18:19], v67 offset:2560
    ds_read_b64 v[20:21], v67 offset:3072
    ds_read_b64 v[22:23], v67 offset:3584
    s_waitcnt lgkmcnt(0)
    v_and_b32 v69, 7, v1
    v_cvt_f32_u32 v106, v69
    v_mul_f32 v106, 0x3c800000, v106
    v_mov_b32 v107, v106
    v_cos_f32 v108, v107
    v_sin_f32 v109, v107
    v_mul_f32 v110, v10, v108
    v_mul_f32 v111, v10, v109
    v_fma_f32 v110, -v11, v109, v110
    v_fma_f32 v111, v11, v108, v111
    v_mul_f32 v112, 0x40000000, v106
    v_cos_f32 v113, v112
    v_sin_f32 v114, v112
    v_mul_f32 v115, v12, v113
    v_mul_f32 v116, v12, v114
    v_fma_f32 v115, -v13, v114, v115
    v_fma_f32 v116, v13, v113, v116
    v_mul_f32 v117, 0x40400000, v106
    v_cos_f32 v118, v117
    v_sin_f32 v119, v117
    v_mul_f32 v120, v14, v118
    v_mul_f32 v121, v14, v119
    v_fma_f32 v120, -v15, v119, v120
    v_fma_f32 v121, v15, v118, v121
    v_mul_f32 v122, 0x40800000, v106
    v_cos_f32 v123, v122
    v_sin_f32 v124, v122
    v_mul_f32 v125, v16, v123
    v_mul_f32 v126, v16, v124
    v_fma_f32 v125, -v17, v124, v125
    v_fma_f32 v126, v17, v123, v126
    v_mul_f32 v127, 0x40a00000, v106
    v_cos_f32 v128, v127
    v_sin_f32 v129, v127
    v_mul_f32 v130, v18, v128
    v_mul_f32 v131, v18, v129
    v_fma_f32 v130, -v19, v129, v130
    v_fma_f32 v131, v19, v128, v131
    v_mul_f32 v132, 0x40c00000, v106
    v_cos_f32 v133, v132
    v_sin_f32 v134, v132
    v_mul_f32 v135, v20, v133
    v_mul_f32 v136, v20, v134
    v_fma_f32 v135, -v21, v134, v135
    v_fma_f32 v136, v21, v133, v136
    v_mul_f32 v137, 0x40e00000, v106
    v_cos_f32 v138, v137
    v_sin_f32 v139, v137
    v_mul_f32 v140, v22, v138
    v_mul_f32 v141, v22, v139
    v_fma_f32 v140, -v23, v139, v140
    v_fma_f32 v141, v23, v138, v141
    v_add_f32 v142, v8, v125
    v_add_f32 v143, v9, v126
    v_sub_f32 v144, v8, v125
    v_sub_f32 v145, v9, v126
    v_add_f32 v146, v110, v130
    v_add_f32 v147, v111, v131
    v_sub_f32 v148, v110, v130
    v_sub_f32 v149, v111, v131
    v_add_f32 v150, v115, v135
    v_add_f32 v151, v116, v136
    v_sub_f32 v152, v115, v135
    v_sub_f32 v153, v116, v136
    v_add_f32 v154, v120, v140
    v_add_f32 v155, v121, v141
    v_sub_f32 v156, v120, v140
    v_sub_f32 v157, v121, v141
    v_sub_f32 v158, v148, v149
    v_add_f32 v159, v148, v149
    v_mul_f32 v158, s16, v158
    v_mul_f32 v159, s16, v159
    v_add_f32 v32, v156, v157
    v_sub_f32 v33, v156, v157
    v_mul_f32_e64 v32, -v32, s16
    v_mul_f32 v33, s16, v33
    v_add_f32 v35, v142, v150
    v_add_f32 v44, v143, v151
    v_sub_f32 v45, v142, v150
    v_sub_f32 v46, v143, v151
    v_add_f32 v47, v146, v154
    v_add_f32 v48, v147, v155
    v_sub_f32 v49, v146, v154
    v_sub_f32 v50, v147, v155
    v_add_f32 v10, v35, v47
    v_add_f32 v11, v44, v48
    v_sub_f32 v18, v35, v47
    v_sub_f32 v19, v44, v48
    v_sub_f32 v14, v45, v50
    v_add_f32 v15, v46, v49
    v_add_f32 v22, v45, v50
    v_sub_f32 v23, v46, v49
    v_sub_f32 v26, v144, v153
    v_add_f32 v27, v145, v152
    v_add_f32 v28, v144, v153
    v_sub_f32 v29, v145, v152
    v_add_f32 v30, v158, v32
    v_add_f32 v31, v159, v33
    v_sub_f32 v36, v158, v32
    v_sub_f32 v37, v159, v33
    v_add_f32 v12, v26, v30
    v_add_f32 v13, v27, v31
    v_sub_f32 v20, v26, v30
    v_sub_f32 v21, v27, v31
    v_sub_f32 v16, v28, v37
    v_add_f32 v17, v29, v36
    v_add_f32 v24, v28, v37
    v_sub_f32 v25, v29, v36
    v_lshrrev_b32 v68, 3, v1
    v_lshl_add_u32 v68, v68, 9, v34
    v_lshl_add_u32 v68, v69, 3, v68
    ds_write_b64 v68, v[10:11] offset:0
    ds_write_b64 v68, v[12:13] offset:64
    ds_write_b64 v68, v[14:15] offset:128
    ds_write_b64 v68, v[16:17] offset:192
    ds_write_b64 v68, v[18:19] offset:256
    ds_write_b64 v68, v[20:21] offset:320
    ds_write_b64 v68, v[22:23] offset:384
    ds_write_b64 v68, v[24:25] offset:448
    s_waitcnt lgkmcnt(0)
    ds_read_b64 v[10:11], v67 offset:0
    ds_read_b64 v[12:13], v67 offset:512
    ds_read_b64 v[14:15], v67 offset:1024
    ds_read_b64 v[16:17], v67 offset:1536
    ds_read_b64 v[18:19], v67 offset:2048
    ds_read_b64 v[20:21], v67 offset:2560
    ds_read_b64 v[22:23], v67 offset:3072
    ds_read_b64 v[24:25], v67 offset:3584
    s_waitcnt lgkmcnt(0)
    v_cvt_f32_u32 v38, v1
    v_mul_f32 v38, 0x3b000000, v38
    v_mov_b32 v39, v38
    v_cos_f32 v40, v39
    v_sin_f32 v41, v39
    v_mul_f32 v42, v12, v40
    v_mul_f32 v43, v12, v41
    v_fma_f32 v42, -v13, v41, v42
    v_fma_f32 v43, v13, v40, v43
    v_mul_f32 v51, 0x40000000, v38
    v_cos_f32 v52, v51
    v_sin_f32 v59, v51
    v_mul_f32 v60, v14, v52
    v_mul_f32 v53, v14, v59
    v_fma_f32 v60, -v15, v59, v60
    v_fma_f32 v53, v15, v52, v53
    v_mul_f32 v54, 0x40400000, v38
    v_cos_f32 v61, v54
    v_sin_f32 v62, v54
    v_mul_f32 v55, v16, v61
    v_mul_f32 v56, v16, v62
    v_fma_f32 v55, -v17, v62, v55
    v_fma_f32 v56, v17, v61, v56
    v_mul_f32 v63, 0x40800000, v38
    v_cos_f32 v64, v63
    v_sin_f32 v57, v63
    v_mul_f32 v58, v18, v64
    v_mul_f32 v65, v18, v57
    v_fma_f32 v58, -v19, v57, v58
    v_fma_f32 v65, v19, v64, v65
    v_mul_f32 v66, 0x40a00000, v38
    v_cos_f32 v76, v66
    v_sin_f32 v77, v66
    v_mul_f32 v84, v20, v76
    v_mul_f32 v85, v20, v77
    v_fma_f32 v84, -v21, v77, v84
    v_fma_f32 v85, v21, v76, v85
    v_mul_f32 v70, 0x40c00000, v38
    v_cos_f32 v71, v70
    v_sin_f32 v78, v70
    v_mul_f32 v79, v22, v71
    v_mul_f32 v74, v22, v78
    v_fma_f32 v79, -v23, v78, v79
    v_fma_f32 v74, v23, v71, v74
    v_mul_f32 v75, 0x40e00000, v38
    v_cos_f32 v82, v75
    v_sin_f32 v83, v75
    v_mul_f32 v90, v24, v82
    v_mul_f32 v91, v24, v83
    v_fma_f32 v90, -v25, v83, v90
    v_fma_f32 v91, v25, v82, v91
    v_add_f32 v94, v10, v58
    v_add_f32 v95, v11, v65
    v_sub_f32 v92, v10, v58
    v_sub_f32 v93, v11, v65
    v_add_f32 v96, v42, v84
    v_add_f32 v97, v43, v85
    v_sub_f32 v72, v42, v84
    v_sub_f32 v73, v43, v85
    v_add_f32 v80, v60, v79
    v_add_f32 v81, v53, v74
    v_sub_f32 v86, v60, v79
    v_sub_f32 v87, v53, v74
    v_add_f32 v88, v55, v90
    v_add_f32 v89, v56, v91
    v_sub_f32 v98, v55, v90
    v_sub_f32 v99, v56, v91
    v_sub_f32 v102, v72, v73
    v_add_f32 v103, v72, v73
    v_mul_f32 v102, s16, v102
    v_mul_f32 v103, s16, v103
    v_add_f32 v100, v98, v99
    v_sub_f32 v101, v98, v99
    v_mul_f32_e64 v100, -v100, s16
    v_mul_f32 v101, s16, v101
    v_add_f32 v104, v94, v80
    v_add_f32 v105, v95, v81
    v_sub_f32 v107, v94, v80
    v_sub_f32 v108, v95, v81
    v_add_f32 v109, v96, v88
    v_add_f32 v112, v97, v89
    v_sub_f32 v113, v96, v88
    v_sub_f32 v114, v97, v89
    v_add_f32 v117, v104, v109
    v_add_f32 v118, v105, v112
    v_sub_f32 v119, v104, v109
    v_sub_f32 v122, v105, v112
    v_sub_f32 v123, v107, v114
    v_add_f32 v124, v108, v113
    v_add_f32 v127, v107, v114
    v_sub_f32 v128, v108, v113
    v_sub_f32 v129, v92, v87
    v_add_f32 v132, v93, v86
    v_add_f32 v133, v92, v87
    v_sub_f32 v134, v93, v86
    v_add_f32 v137, v102, v100
    v_add_f32 v138, v103, v101
    v_sub_f32 v139, v102, v100
    v_sub_f32 v106, v103, v101
    v_add_f32 v8, v129, v137
    v_add_f32 v9, v132, v138
    v_sub_f32 v125, v129, v137
    v_sub_f32 v126, v132, v138
    v_sub_f32 v110, v133, v106
    v_add_f32 v111, v134, v139
    v_add_f32 v130, v133, v106
    v_sub_f32 v131, v134, v139
    s_lshl_b32 s17, s2, 13
    v_lshlrev_b32 v3, 11, v2
    v_lshl_add_u32 v3, v1, 1, v3
    v_add_u32 v3, s17, v3
    s_mov_b32 s18, 29360128
    buffer_load_ushort v115, v3, s[8:11], 0 offen offset:0
    buffer_load_ushort v148, v3, s[8:11], 0 offen offset:1024
    buffer_load_ushort v146, v3, s[12:15], s18 offen offset:0
    buffer_load_ushort v45, v3, s[12:15], s18 offen offset:1024
    buffer_load_ushort v116, v3, s[8:11], 0 offen offset:128
    buffer_load_ushort v149, v3, s[8:11], 0 offen offset:1152
    buffer_load_ushort v147, v3, s[12:15], s18 offen offset:128
    buffer_load_ushort v46, v3, s[12:15], s18 offen offset:1152
    buffer_load_ushort v135, v3, s[8:11], 0 offen offset:256
    buffer_load_ushort v156, v3, s[8:11], 0 offen offset:1280
    buffer_load_ushort v154, v3, s[12:15], s18 offen offset:256
    buffer_load_ushort v49, v3, s[12:15], s18 offen offset:1280
    buffer_load_ushort v136, v3, s[8:11], 0 offen offset:384
    buffer_load_ushort v157, v3, s[8:11], 0 offen offset:1408
    buffer_load_ushort v155, v3, s[12:15], s18 offen offset:384
    buffer_load_ushort v50, v3, s[12:15], s18 offen offset:1408
    buffer_load_ushort v120, v3, s[8:11], 0 offen offset:512
    buffer_load_ushort v142, v3, s[8:11], 0 offen offset:1536
    buffer_load_ushort v35, v3, s[12:15], s18 offen offset:512
    buffer_load_ushort v144, v3, s[12:15], s18 offen offset:1536
    buffer_load_ushort v121, v3, s[8:11], 0 offen offset:640
    buffer_load_ushort v143, v3, s[8:11], 0 offen offset:1664
    buffer_load_ushort v44, v3, s[12:15], s18 offen offset:640
    buffer_load_ushort v145, v3, s[12:15], s18 offen offset:1664
    buffer_load_ushort v140, v3, s[8:11], 0 offen offset:768
    buffer_load_ushort v150, v3, s[8:11], 0 offen offset:1792
    buffer_load_ushort v47, v3, s[12:15], s18 offen offset:768
    buffer_load_ushort v152, v3, s[12:15], s18 offen offset:1792
    buffer_load_ushort v141, v3, s[8:11], 0 offen offset:896
    buffer_load_ushort v151, v3, s[8:11], 0 offen offset:1920
    buffer_load_ushort v48, v3, s[12:15], s18 offen offset:896
    buffer_load_ushort v153, v3, s[12:15], s18 offen offset:1920
    s_waitcnt vmcnt(0)
    v_cvt_pk_bf16_f32 v158, v117, v118
    v_lshlrev_b32 v117, 16, v158
    v_and_b32 v118, 0xffff0000, v158
    v_lshlrev_b32 v146, 16, v146
    v_lshlrev_b32 v45, 16, v45
    v_lshlrev_b32 v115, 16, v115
    v_lshlrev_b32 v148, 16, v148
    v_mul_f32 v117, v117, v146
    v_mul_f32 v118, v118, v45
    v_cvt_pk_bf16_f32 v159, v117, v118
    v_lshlrev_b32 v117, 16, v159
    v_and_b32 v118, 0xffff0000, v159
    v_add_f32 v117, v117, v115
    v_add_f32 v118, v118, v148
    v_cvt_pk_bf16_f32 v115, v117, v118
    buffer_store_short v115, v3, s[32:35], 0 offen offset:0
    buffer_store_short_d16_hi v115, v3, s[32:35], 0 offen offset:1024
    v_cvt_pk_bf16_f32 v32, v8, v9
    v_lshlrev_b32 v8, 16, v32
    v_and_b32 v9, 0xffff0000, v32
    v_lshlrev_b32 v147, 16, v147
    v_lshlrev_b32 v46, 16, v46
    v_lshlrev_b32 v116, 16, v116
    v_lshlrev_b32 v149, 16, v149
    v_mul_f32 v8, v8, v147
    v_mul_f32 v9, v9, v46
    v_cvt_pk_bf16_f32 v33, v8, v9
    v_lshlrev_b32 v8, 16, v33
    v_and_b32 v9, 0xffff0000, v33
    v_add_f32 v8, v8, v116
    v_add_f32 v9, v9, v149
    v_cvt_pk_bf16_f32 v116, v8, v9
    buffer_store_short v116, v3, s[32:35], 0 offen offset:128
    buffer_store_short_d16_hi v116, v3, s[32:35], 0 offen offset:1152
    v_cvt_pk_bf16_f32 v26, v123, v124
    v_lshlrev_b32 v123, 16, v26
    v_and_b32 v124, 0xffff0000, v26
    v_lshlrev_b32 v154, 16, v154
    v_lshlrev_b32 v49, 16, v49
    v_lshlrev_b32 v135, 16, v135
    v_lshlrev_b32 v156, 16, v156
    v_mul_f32 v123, v123, v154
    v_mul_f32 v124, v124, v49
    v_cvt_pk_bf16_f32 v27, v123, v124
    v_lshlrev_b32 v123, 16, v27
    v_and_b32 v124, 0xffff0000, v27
    v_add_f32 v123, v123, v135
    v_add_f32 v124, v124, v156
    v_cvt_pk_bf16_f32 v135, v123, v124
    buffer_store_short v135, v3, s[32:35], 0 offen offset:256
    buffer_store_short_d16_hi v135, v3, s[32:35], 0 offen offset:1280
    v_cvt_pk_bf16_f32 v30, v110, v111
    v_lshlrev_b32 v110, 16, v30
    v_and_b32 v111, 0xffff0000, v30
    v_lshlrev_b32 v155, 16, v155
    v_lshlrev_b32 v50, 16, v50
    v_lshlrev_b32 v136, 16, v136
    v_lshlrev_b32 v157, 16, v157
    v_mul_f32 v110, v110, v155
    v_mul_f32 v111, v111, v50
    v_cvt_pk_bf16_f32 v31, v110, v111
    v_lshlrev_b32 v110, 16, v31
    v_and_b32 v111, 0xffff0000, v31
    v_add_f32 v110, v110, v136
    v_add_f32 v111, v111, v157
    v_cvt_pk_bf16_f32 v136, v110, v111
    buffer_store_short v136, v3, s[32:35], 0 offen offset:384
    buffer_store_short_d16_hi v136, v3, s[32:35], 0 offen offset:1408
    v_cvt_pk_bf16_f32 v28, v119, v122
    v_lshlrev_b32 v119, 16, v28
    v_and_b32 v122, 0xffff0000, v28
    v_lshlrev_b32 v35, 16, v35
    v_lshlrev_b32 v144, 16, v144
    v_lshlrev_b32 v120, 16, v120
    v_lshlrev_b32 v142, 16, v142
    v_mul_f32 v119, v119, v35
    v_mul_f32 v122, v122, v144
    v_cvt_pk_bf16_f32 v29, v119, v122
    v_lshlrev_b32 v119, 16, v29
    v_and_b32 v122, 0xffff0000, v29
    v_add_f32 v119, v119, v120
    v_add_f32 v122, v122, v142
    v_cvt_pk_bf16_f32 v120, v119, v122
    buffer_store_short v120, v3, s[32:35], 0 offen offset:512
    buffer_store_short_d16_hi v120, v3, s[32:35], 0 offen offset:1536
    v_cvt_pk_bf16_f32 v36, v125, v126
    v_lshlrev_b32 v125, 16, v36
    v_and_b32 v126, 0xffff0000, v36
    v_lshlrev_b32 v44, 16, v44
    v_lshlrev_b32 v145, 16, v145
    v_lshlrev_b32 v121, 16, v121
    v_lshlrev_b32 v143, 16, v143
    v_mul_f32 v125, v125, v44
    v_mul_f32 v126, v126, v145
    v_cvt_pk_bf16_f32 v37, v125, v126
    v_lshlrev_b32 v125, 16, v37
    v_and_b32 v126, 0xffff0000, v37
    v_add_f32 v125, v125, v121
    v_add_f32 v126, v126, v143
    v_cvt_pk_bf16_f32 v121, v125, v126
    buffer_store_short v121, v3, s[32:35], 0 offen offset:640
    buffer_store_short_d16_hi v121, v3, s[32:35], 0 offen offset:1664
    v_cvt_pk_bf16_f32 v12, v127, v128
    v_lshlrev_b32 v127, 16, v12
    v_and_b32 v128, 0xffff0000, v12
    v_lshlrev_b32 v47, 16, v47
    v_lshlrev_b32 v152, 16, v152
    v_lshlrev_b32 v140, 16, v140
    v_lshlrev_b32 v150, 16, v150
    v_mul_f32 v127, v127, v47
    v_mul_f32 v128, v128, v152
    v_cvt_pk_bf16_f32 v13, v127, v128
    v_lshlrev_b32 v127, 16, v13
    v_and_b32 v128, 0xffff0000, v13
    v_add_f32 v127, v127, v140
    v_add_f32 v128, v128, v150
    v_cvt_pk_bf16_f32 v140, v127, v128
    buffer_store_short v140, v3, s[32:35], 0 offen offset:768
    buffer_store_short_d16_hi v140, v3, s[32:35], 0 offen offset:1792
    v_cvt_pk_bf16_f32 v39, v130, v131
    v_lshlrev_b32 v130, 16, v39
    v_and_b32 v131, 0xffff0000, v39
    v_lshlrev_b32 v48, 16, v48
    v_lshlrev_b32 v153, 16, v153
    v_lshlrev_b32 v141, 16, v141
    v_lshlrev_b32 v151, 16, v151
    v_mul_f32 v130, v130, v48
    v_mul_f32 v131, v131, v153
    v_cvt_pk_bf16_f32 v40, v130, v131
    v_lshlrev_b32 v130, 16, v40
    v_and_b32 v131, 0xffff0000, v40
    v_add_f32 v130, v130, v141
    v_add_f32 v131, v131, v151
    v_cvt_pk_bf16_f32 v141, v130, v131
    buffer_store_short v141, v3, s[32:35], 0 offen offset:896
    buffer_store_short_d16_hi v141, v3, s[32:35], 0 offen offset:1920
Lend_k4:
    s_endpgm
.section .rodata,"a"
.p2align 6
.amdhsa_kernel l1_kernel
  .amdhsa_next_free_vgpr 160
  .amdhsa_next_free_sgpr 102
  .amdhsa_accum_offset 160
  .amdhsa_group_segment_fixed_size 0
  .amdhsa_kernarg_size 72
  .amdhsa_user_sgpr_count 2
  .amdhsa_user_sgpr_kernarg_segment_ptr 1
  .amdhsa_system_sgpr_workgroup_id_x 1
.end_amdhsa_kernel
.p2align 6
.amdhsa_kernel l2_kernel
  .amdhsa_next_free_vgpr 200
  .amdhsa_next_free_sgpr 102
  .amdhsa_accum_offset 200
  .amdhsa_group_segment_fixed_size 0
  .amdhsa_kernarg_size 72
  .amdhsa_user_sgpr_count 2
  .amdhsa_user_sgpr_kernarg_segment_ptr 1
  .amdhsa_system_sgpr_workgroup_id_x 1
.end_amdhsa_kernel
.p2align 6
.amdhsa_kernel k4_kernel
  .amdhsa_next_free_vgpr 160
  .amdhsa_next_free_sgpr 102
  .amdhsa_accum_offset 160
  .amdhsa_group_segment_fixed_size 0
  .amdhsa_kernarg_size 72
  .amdhsa_user_sgpr_count 2
  .amdhsa_user_sgpr_kernarg_segment_ptr 1
  .amdhsa_system_sgpr_workgroup_id_x 1
.end_amdhsa_kernel
```
